```python
import torch

def _softmax(x, axis=-1):
    return torch.softmax(x, dim=axis)
def _gelu(x):
    return torch.nn.functional.gelu(x, approximate="tanh")
def _silu(x):
    return torch.nn.functional.silu(x)
def _sigmoid(x):
    return torch.sigmoid(x)
def _layernorm(x, axis=-1, eps=1e-5):
    m = x.mean(dim=axis, keepdim=True)
    v = x.var(dim=axis, keepdim=True, unbiased=False)
    return (x - m) / torch.sqrt(v + eps)
def _scatter_add(tgt, idx, src, axis=0):
    return tgt.clone().index_add_(axis, idx, src)
def _segment_sum(src, seg, n):
    out = torch.zeros((n,) + src.shape[1:], dtype=src.dtype)
    return out.index_add_(0, seg, src)
def _pad(x, pw):
    flat = tuple(v for pair in reversed(pw) for v in pair)
    return torch.nn.functional.pad(x, flat)

kernel_name = 'concat_heads__gqa_block_cached__sliding_block_cached__decode'

def setup_inputs():

    _w = (lambda a: (lambda t: t.to(torch.bfloat16) if t.is_floating_point() else t)(torch.as_tensor(a)))
    def _A_setup():
        B, Sq, D = 1, 1, 1024
        Hq, Hkv, Sk, Dh = 32, 4, 65536, 128
        assert Hq % Hkv == 0, (Hq, Hkv)
        return {
            "x": _w((lambda *s: torch.randn(*s, dtype=torch.bfloat16) * 0.4)(B, Sq, D)),
            "k_cache": _w((lambda *s: torch.randn(*s, dtype=torch.bfloat16) * 3.2)(B, Hkv, Sk, Dh)),
            "v_cache": _w((lambda *s: torch.randn(*s, dtype=torch.bfloat16) * 0.8)(B, Hkv, Sk, Dh)),
            "wq": _w((lambda *s: torch.randn(*s, dtype=torch.bfloat16) * 3.2)(D, Hq * Dh) * (D ** -0.5)),
            "wo": _w((lambda *s: torch.randn(*s, dtype=torch.bfloat16) * 0.8)(Hq * Dh, D) * ((Hq * Dh) ** -0.5)),
        }
    _A_in = _A_setup()

    def _B_setup():
        B, Sq, D = 1, 1, 1024
        Hq, Hkv, Sk, Dh = 32, 4, 65536, 128
        assert Hq % Hkv == 0, (Hq, Hkv)
        return {
            "x": _w((lambda *s: torch.randn(*s, dtype=torch.bfloat16) * 0.2)(B, Sq, D)),
            "k_cache": _w((lambda *s: torch.randn(*s, dtype=torch.bfloat16) * 3.2)(B, Hkv, Sk, Dh)),
            "v_cache": _w((lambda *s: torch.randn(*s, dtype=torch.bfloat16) * 1.6)(B, Hkv, Sk, Dh)),
            "wq": _w((lambda *s: torch.randn(*s, dtype=torch.bfloat16) * 3.2)(D, Hq * Dh) * (D ** -0.5)),
            "wo": _w((lambda *s: torch.randn(*s, dtype=torch.bfloat16) * 1.6)(Hq * Dh, D) * ((Hq * Dh) ** -0.5)),
        }
    _B_in = _B_setup()

    return {
        "A_x": _A_in["x"],
        "A_k_cache": _A_in["k_cache"],
        "A_v_cache": _A_in["v_cache"],
        "A_wq": _A_in["wq"],
        "A_wo": _A_in["wo"],
        "B_x": _B_in["x"],
        "B_k_cache": _B_in["k_cache"],
        "B_v_cache": _B_in["v_cache"],
        "B_wq": _B_in["wq"],
        "B_wo": _B_in["wo"],
    }

def reference(A_x, A_k_cache, A_v_cache, A_wq, A_wo, B_x, B_k_cache, B_v_cache, B_wq, B_wo):
    def _A_ref(x, k_cache, v_cache, wq, wo):
        B, Sq, D = x.shape
        Hq, Dh = 32, 128
        Hkv = k_cache.shape[1]
        rep = Hq // Hkv
        q = (lambda x, *d: x.permute(*d))((x @ wq).reshape(B, Sq, Hq, Dh), 0, 2, 1, 3)
        k = (lambda x, n, axis: torch.repeat_interleave(x, n, dim=axis))(k_cache, rep, axis=1)
        v = (lambda x, n, axis: torch.repeat_interleave(x, n, dim=axis))(v_cache, rep, axis=1)
        scores = torch.einsum("bhqd,bhkd->bhqk", q, k) * (Dh ** -0.5)
        p = _softmax(scores, axis=-1)
        o = torch.einsum("bhqk,bhkd->bhqd", p, v)
        return (lambda x, *d: x.permute(*d))(o, 0, 2, 1, 3).reshape(B, Sq, Hq * Dh) @ wo

    def _B_ref(x, k_cache, v_cache, wq, wo):
        B, Sq, D = x.shape
        Hq, Dh = 32, 128
        Hkv, Sk = k_cache.shape[1], k_cache.shape[2]
        W = min(4096, max(256, Sk // 4))
        rep = Hq // Hkv
        q = (lambda x, *d: x.permute(*d))((x @ wq).reshape(B, Sq, Hq, Dh), 0, 2, 1, 3)
        k = (lambda x, n, axis: torch.repeat_interleave(x, n, dim=axis))(k_cache[:, :, Sk - W:, :], rep, axis=1)
        v = (lambda x, n, axis: torch.repeat_interleave(x, n, dim=axis))(v_cache[:, :, Sk - W:, :], rep, axis=1)
        scores = torch.einsum("bhqd,bhkd->bhqk", q, k) * (Dh ** -0.5)
        p = _softmax(scores, axis=-1)
        o = torch.einsum("bhqk,bhkd->bhqd", p, v)
        return (lambda x, *d: x.permute(*d))(o, 0, 2, 1, 3).reshape(B, Sq, Hq * Dh) @ wo

    a = _A_ref(A_x, A_k_cache, A_v_cache, A_wq, A_wo)
    b = _B_ref(B_x, B_k_cache, B_v_cache, B_wq, B_wo)
    return torch.concatenate([a, b], axis=-1)
```

```asm
; @launch grid=(256,1,1) block=(1024,1,1) lds=91392
.amdgcn_target "amdgcn-amd-amdhsa--gfx950"
.text
.globl concat_heads__gqa_block_cached__sliding_block_cached__decode_kernel
.p2align 8
.type concat_heads__gqa_block_cached__sliding_block_cached__decode_kernel,@function
concat_heads__gqa_block_cached__sliding_block_cached__decode_kernel:
    s_cmp_ge_u32 s2, 256
    s_cbranch_scc1 L_end
    s_load_dwordx16 s[4:19], s[0:1], 0
    s_load_dwordx8 s[20:27], s[0:1], 64
    s_load_dwordx2 s[28:29], s[0:1], 96
    v_lshrrev_b32 v5, 6, v0
    v_mov_b32 v4, 0
    v_readfirstlane_b32 s3, v5
    v_and_b32 v0, 63, v0
    v_lshrrev_b32 v8, 4, v0
    v_and_b32 v7, 7, v0
    v_lshlrev_b32 v10, 2, v7
    v_and_b32 v12, 8, v0
    v_lshlrev_b32 v14, 15, v12
    v_lshl_add_u32 v14, v8, 16, v14
    v_lshl_add_u32 v14, v10, 2, v14
    v_and_b32 v2, 1, v0
    v_lshlrev_b32 v15, 6, v2
    v_lshl_add_u32 v15, v8, 4, v15
    s_and_b32 s49, s2, 1
    s_lshl_b32 s49, s49, 9
    s_lshl_b32 s48, s3, 6
    s_add_u32 s49, s49, s48
    s_bfe_u32 s52, s2, 0x60001
    s_lshl_b32 s48, s49, 13
    s_lshl_b32 s50, s52, 7
    s_add_u32 s48, s48, s50
    s_lshl_b32 s49, s49, 1
    v_add_u32 v15, s49, v15
    s_mov_b32 s42, 0x800000
    s_mov_b32 s43, 0x20000
    s_setprio 2
    s_cmp_lt_u32 s2, 128
    s_waitcnt lgkmcnt(0)
    s_load_dword s54, s[28:29], 0
    s_cselect_b32 s40, s10, s20
    s_cselect_b32 s41, s11, s21
    s_cselect_b32 s66, s4, s14
    s_cselect_b32 s67, s5, s15
    s_cselect_b32 s10, s12, s22
    s_cselect_b32 s11, s13, s23
    s_cmp_ge_u32 s3, 8
    s_cbranch_scc1 L_nowq
    buffer_load_dwordx4 v[64:67], v14, s[40:43], s48 offen nt
    s_add_u32 s48, s48, 8192
    buffer_load_dwordx4 v[68:71], v14, s[40:43], s48 offen nt
    s_add_u32 s48, s48, 8192
    buffer_load_dwordx4 v[72:75], v14, s[40:43], s48 offen nt
    s_add_u32 s48, s48, 8192
    buffer_load_dwordx4 v[76:79], v14, s[40:43], s48 offen nt
    s_add_u32 s48, s48, 8192
    buffer_load_dwordx4 v[80:83], v14, s[40:43], s48 offen nt
    s_add_u32 s48, s48, 8192
    buffer_load_dwordx4 v[84:87], v14, s[40:43], s48 offen nt
    s_add_u32 s48, s48, 8192
    buffer_load_dwordx4 v[88:91], v14, s[40:43], s48 offen nt
    s_add_u32 s48, s48, 8192
    buffer_load_dwordx4 v[92:95], v14, s[40:43], s48 offen nt
    global_load_dwordx4 v[16:19], v15, s[66:67]
L_nowq:
    v_mov_b32 v6, 1
    v_lshlrev_b32 v1, 4, v0
    v_and_b32 v57, 3, v5
    v_lshl_add_u32 v11, v57, 12, v1
    v_and_b32 v9, 15, v0
    v_lshrrev_b32 v13, 2, v9
    v_lshlrev_b32 v2, 4, v2
    v_lshl_add_u32 v2, v13, 8, v2
    v_lshl_add_u32 v2, v8, 5, v2
    v_and_b32 v13, 2, v0
    v_lshl_add_u32 v2, v13, 10, v2
    v_mul_u32_u24 v3, 272, v7
    v_lshl_add_u32 v3, v8, 5, v3
    v_lshl_add_u32 v3, v12, 1, v3
    s_mov_b32 s30, 0x05040100
    s_mov_b32 s31, 0x07060302
    s_mov_b32 s100, 0xffff0000
    s_mov_b32 s101, 0x3db504f3
    s_lshr_b32 s20, s2, 7
    s_lshr_b32 s22, s2, 6
    s_and_b32 s23, s2, 63
    s_bfe_u32 s48, s2, 0x20003
    s_xor_b32 s48, s48, 1
    s_lshr_b32 s49, s3, 2
    s_or_b32 s49, s49, s48
    s_cselect_b32 s32, s6, s16
    s_cselect_b32 s33, s7, s17
    s_mov_b32 s34, 0x4000000
    s_mov_b32 s35, 0x20000
    s_cselect_b32 s36, s8, s18
    s_cselect_b32 s37, s9, s19
    s_mov_b32 s38, 0x4000000
    s_mov_b32 s39, 0x20000
    s_cselect_b32 s17, 0, 1
    s_cmp_eq_u32 s48, 0
    s_cselect_b32 s16, 1, 0
    s_cselect_b32 s18, 8, 12
    s_cmp_eq_u32 s17, 0
    s_cselect_b32 s18, s18, 4
    s_mul_i32 s48, s17, 2304
    v_add_u32 v3, s48, v3
    s_mov_b32 s44, s28
    s_mov_b32 s45, s29
    s_mov_b32 s46, 4194304
    s_mov_b32 s47, 0x20000
    s_and_b32 s4, s2, 7
    s_bfe_u32 s7, s2, 0x30004
    s_lshl_b32 s7, s7, 3
    s_add_u32 s4, s4, s7
    s_bfe_u32 s7, s2, 0x10003
    s_mov_b32 s14, 0x00ff00ff
    s_mov_b32 s15, 0x00ff00ff
    s_lshl_b32 s48, s23, 7
    s_mul_i32 s6, s22, 270336
    s_add_u32 s6, s6, s48
    s_add_u32 s6, s6, 655360
    s_mul_i32 s5, s22, 33792
    s_add_u32 s5, s5, s48
    s_add_u32 s5, s5, 327680
    s_lshr_b32 s0, s23, 5
    s_lshl_b32 s19, s0, 3
    s_and_b32 s48, s23, 7
    s_add_u32 s19, s19, s48
    s_add_u32 s1, s22, 3
    s_and_b32 s1, s1, 3
    s_lshl_b32 s1, s1, 8
    s_lshl_b32 s48, s0, 7
    s_add_u32 s1, s1, s48
    s_lshr_b32 s48, s3, 2
    s_add_u32 s49, s48, s22
    s_and_b32 s49, s49, 3
    s_lshl_b32 s49, s49, 22
    s_lshl_b32 s50, s23, 16
    s_add_u32 s49, s49, s50
    s_lshl_b32 s50, s19, 16
    s_add_u32 s50, s50, 15728640
    s_cmp_eq_u32 s17, 0
    s_cselect_b32 s96, s49, s50
    s_lshl_b32 s48, s22, 24
    s_add_u32 s96, s96, s48
    s_and_b32 s48, s3, 3
    s_lshl_b32 s48, s48, 12
    s_add_u32 s96, s96, s48
    s_add_u32 s97, s96, 16384
    s_add_u32 s98, s96, 32768
    s_add_u32 s99, s96, 49152
    s_cmp_ge_u32 s3, 8
    s_cbranch_scc1 L_young0
    s_lshr_b32 s56, s2, 5
    s_mul_i32 s56, s56, 33792
    s_and_b32 s48, s2, 1
    s_lshl_b32 s48, s48, 12
    s_add_u32 s56, s56, s48
    s_and_b32 s48, s52, 15
    s_lshl_b32 s48, s48, 8
    s_add_u32 s56, s56, s48
    s_add_u32 s56, s56, 16384
    v_mul_u32_u24 v60, 8448, v8
    v_lshl_add_u32 v60, v9, 4, v60
    v_lshlrev_b32 v7, 3, v10
    v_lshl_add_u32 v7, v12, 1, v7
    s_lshl_b32 s48, s3, 8
    v_add_u32 v7, s48, v7
    v_mov_b32 v56, 0xffffff00
    s_waitcnt lgkmcnt(0)
    s_barrier
    s_and_b32 s55, s54, 0x7f7f7f7f
    s_add_u32 s55, s55, 0x35172b4d
    s_and_b32 s8, s54, 0x80808080
    s_xor_b32 s55, s55, s8
    s_and_b32 s8, s55, 0xff
    s_bfe_u32 s9, s55, 0x80008
    s_bfe_u32 s12, s55, 0x80010
    s_lshr_b32 s13, s55, 24
    s_waitcnt vmcnt(0)
    v_perm_b32 v96, v68, v64, s30
    v_perm_b32 v97, v76, v72, s30
    v_perm_b32 v98, v84, v80, s30
    v_perm_b32 v99, v92, v88, s30
    v_perm_b32 v100, v68, v64, s31
    v_perm_b32 v101, v76, v72, s31
    v_perm_b32 v102, v84, v80, s31
    v_perm_b32 v103, v92, v88, s31
    v_perm_b32 v104, v69, v65, s30
    v_perm_b32 v105, v77, v73, s30
    v_perm_b32 v106, v85, v81, s30
    v_perm_b32 v107, v93, v89, s30
    v_perm_b32 v108, v69, v65, s31
    v_perm_b32 v109, v77, v73, s31
    v_perm_b32 v110, v85, v81, s31
    v_perm_b32 v111, v93, v89, s31
    v_perm_b32 v112, v70, v66, s30
    v_perm_b32 v113, v78, v74, s30
    v_perm_b32 v114, v86, v82, s30
    v_perm_b32 v115, v94, v90, s30
    v_perm_b32 v116, v70, v66, s31
    v_perm_b32 v117, v78, v74, s31
    v_perm_b32 v118, v86, v82, s31
    v_perm_b32 v119, v94, v90, s31
    v_perm_b32 v120, v71, v67, s30
    v_perm_b32 v121, v79, v75, s30
    v_perm_b32 v122, v87, v83, s30
    v_perm_b32 v123, v95, v91, s30
    v_perm_b32 v124, v71, v67, s31
    v_perm_b32 v125, v79, v75, s31
    v_perm_b32 v126, v87, v83, s31
    v_perm_b32 v127, v95, v91, s31
    s_nop 1
    v_mfma_f32_16x16x32_bf16 v[24:27], v[16:19], v[96:99], 0
    v_mfma_f32_16x16x32_bf16 v[40:43], v[16:19], v[112:115], 0
    v_mfma_f32_16x16x32_bf16 v[28:31], v[16:19], v[100:103], 0
    v_mfma_f32_16x16x32_bf16 v[44:47], v[16:19], v[116:119], 0
    v_mfma_f32_16x16x32_bf16 v[32:35], v[16:19], v[104:107], 0
    v_mfma_f32_16x16x32_bf16 v[48:51], v[16:19], v[120:123], 0
    v_mfma_f32_16x16x32_bf16 v[36:39], v[16:19], v[108:111], 0
    v_mfma_f32_16x16x32_bf16 v[52:55], v[16:19], v[124:127], 0
    s_nop 1
    v_cndmask_b32 v26, v41, v24, s[14:15]
    v_cndmask_b32 v27, v25, v40, s[14:15]
    v_cndmask_b32 v30, v45, v28, s[14:15]
    v_cndmask_b32 v31, v29, v44, s[14:15]
    v_cndmask_b32 v34, v49, v32, s[14:15]
    v_cndmask_b32 v35, v33, v48, s[14:15]
    v_cndmask_b32 v38, v53, v36, s[14:15]
    v_cndmask_b32 v39, v37, v52, s[14:15]
    s_mov_b64 exec, 0xffff
    v_add_f32_dpp v20, v27, v26 row_ror:8 row_mask:0xf bank_mask:0xf
    v_add_f32_dpp v21, v31, v30 row_ror:8 row_mask:0xf bank_mask:0xf
    v_add_f32_dpp v22, v35, v34 row_ror:8 row_mask:0xf bank_mask:0xf
    v_add_f32_dpp v23, v39, v38 row_ror:8 row_mask:0xf bank_mask:0xf
    ds_write_b128 v7, v[20:23] offset:32768
    s_mov_b64 exec, 1
    ds_add_rtn_u32 v5, v4, v6 offset:39552
    s_mov_b64 exec, -1
    s_waitcnt lgkmcnt(0)
    v_readfirstlane_b32 s48, v5
    s_cmp_lg_u32 s48, 7
    s_cbranch_scc1 L_task
    s_setprio 3
    ds_read_b128 v[32:35], v1 offset:32768
    ds_read_b128 v[36:39], v1 offset:33792
    s_waitcnt lgkmcnt(0)
    v_add_f32 v32, v32, v36
    v_add_f32 v33, v33, v37
    v_add_f32 v34, v34, v38
    v_add_f32 v35, v35, v39
    v_mov_b32 v36, v32
    v_mov_b32 v37, v33
    v_mov_b32 v38, v34
    v_mov_b32 v39, v35
    s_nop 1
    v_permlane16_swap_b32 v32, v36
    v_permlane16_swap_b32 v33, v37
    v_permlane16_swap_b32 v34, v38
    v_permlane16_swap_b32 v35, v39
    s_nop 1
    v_add_f32 v32, v32, v36
    v_add_f32 v33, v33, v37
    v_add_f32 v34, v34, v38
    v_add_f32 v35, v35, v39
    v_mov_b32 v36, v32
    v_mov_b32 v37, v33
    v_mov_b32 v38, v34
    v_mov_b32 v39, v35
    s_nop 1
    v_permlane32_swap_b32 v32, v36
    v_permlane32_swap_b32 v33, v37
    v_permlane32_swap_b32 v34, v38
    v_permlane32_swap_b32 v35, v39
    s_nop 1
    v_add_f32 v32, v32, v36
    v_add_f32 v33, v33, v37
    v_add_f32 v34, v34, v38
    v_add_f32 v35, v35, v39
    v_and_or_b32 v32, v32, v56, s8
    v_and_or_b32 v33, v33, v56, s9
    v_and_or_b32 v34, v34, v56, s12
    v_and_or_b32 v35, v35, v56, s13
    s_mov_b64 exec, 0xffffffff
    buffer_store_dwordx4 v[32:35], v60, s[44:47], s56 offen sc1
    s_mov_b64 exec, -1
    s_setprio 2
    s_branch L_task
L_young0:
    v_mov_b32 v5, 0xff800000
    v_cmp_gt_u32 vcc, 16, v0
    v_lshlrev_b32 v7, 2, v0
    s_lshl_b32 s48, s3, 8
    v_cndmask_b32 v5, v4, v5, vcc
    ds_write_b32 v7, v5 offset:39424
    v_add_u32 v9, s48, v7
    ds_write_b32 v9, v4 offset:38144
    s_waitcnt lgkmcnt(0)
    s_barrier
    s_and_b32 s55, s54, 0x7f7f7f7f
    s_add_u32 s55, s55, 0x35172b4d
    s_and_b32 s8, s54, 0x80808080
    s_xor_b32 s55, s55, s8
    s_and_b32 s8, s55, 0xff
    s_bfe_u32 s9, s55, 0x80008
    s_bfe_u32 s12, s55, 0x80010
    s_lshr_b32 s13, s55, 24
    s_cmp_ge_u32 s3, 12
    s_cbranch_scc1 L_dyn
L_task:
    buffer_load_dwordx4 v[64:67], v2, s[32:35], s96 offen offset:0 nt
    s_nop 0
    buffer_load_dwordx4 v[68:71], v2, s[32:35], s96 offen offset:128 nt
    s_nop 0
    buffer_load_dwordx4 v[72:75], v2, s[32:35], s96 offen offset:1024 nt
    s_nop 0
    buffer_load_dwordx4 v[76:79], v2, s[32:35], s96 offen offset:1152 nt
    s_nop 0
    buffer_load_dwordx4 v[80:83], v2, s[32:35], s97 offen offset:0 nt
    s_nop 0
    buffer_load_dwordx4 v[84:87], v2, s[32:35], s97 offen offset:128 nt
    s_nop 0
    buffer_load_dwordx4 v[88:91], v2, s[32:35], s97 offen offset:1024 nt
    s_nop 0
    buffer_load_dwordx4 v[92:95], v2, s[32:35], s97 offen offset:1152 nt
    s_nop 0
    buffer_load_dwordx4 v[96:99], v2, s[32:35], s98 offen offset:0 nt
    s_nop 0
    buffer_load_dwordx4 v[100:103], v2, s[32:35], s98 offen offset:128 nt
    s_nop 0
    buffer_load_dwordx4 v[104:107], v2, s[32:35], s98 offen offset:1024 nt
    s_nop 0
    buffer_load_dwordx4 v[108:111], v2, s[32:35], s98 offen offset:1152 nt
    s_nop 0
    buffer_load_dwordx4 v[112:115], v2, s[32:35], s99 offen offset:0 nt
    s_nop 0
    buffer_load_dwordx4 v[116:119], v2, s[32:35], s99 offen offset:128 nt
    s_nop 0
    buffer_load_dwordx4 v[120:123], v2, s[32:35], s99 offen offset:1024 nt
    s_nop 0
    buffer_load_dwordx4 v[124:127], v2, s[32:35], s99 offen offset:1152 nt
    s_nop 0
    s_sub_u32 s48, s3, 4
    s_cmp_gt_u32 s48, s16
    s_cbranch_scc1 L_nq
    s_and_b32 s48, s3, 1
    v_lshrrev_b32 v8, 5, v0
    v_and_b32 v5, 31, v0
    v_mul_u32_u24 v8, 272, v8
    v_lshl_add_u32 v8, v5, 3, v8
    s_mul_i32 s40, s48, 2304
    v_add_u32 v8, s40, v8
    s_mul_i32 s40, s48, 96
    v_mov_b32 v9, s40
    v_mov_b32 v15, 0xff
    s_lshl_b32 s40, s48, 2
    s_add_u32 s40, s40, s22
    s_lshl_b32 s40, s40, 2
    s_and_b32 s41, s2, 1
    s_add_u32 s40, s40, s41
    s_mul_i32 s40, s40, 8448
    s_add_u32 s40, s40, 16384
    s_add_u32 s41, s40, 4096
    s_setprio 3
    s_mov_b32 s49, 0x20000
    buffer_load_dwordx4 v[32:35], v1, s[44:47], s40 offen offset:0 sc1
    buffer_load_dwordx4 v[36:39], v1, s[44:47], s40 offen offset:1024 sc1
    buffer_load_dwordx4 v[40:43], v1, s[44:47], s40 offen offset:2048 sc1
    buffer_load_dwordx4 v[44:47], v1, s[44:47], s40 offen offset:3072 sc1
    buffer_load_dwordx4 v[48:51], v1, s[44:47], s41 offen offset:0 sc1
    buffer_load_dwordx4 v[52:55], v1, s[44:47], s41 offen offset:1024 sc1
    buffer_load_dwordx4 v[56:59], v1, s[44:47], s41 offen offset:2048 sc1
    buffer_load_dwordx4 v[60:63], v1, s[44:47], s41 offen offset:3072 sc1
    s_waitcnt vmcnt(7)
    v_xor_b32 v32, s8, v32
    v_xor_b32 v33, s9, v33
    v_xor_b32 v34, s12, v34
    v_xor_b32 v35, s13, v35
    v_or3_b32 v5, v32, v33, v34
    v_bitop3_b32 v5, v5, v15, v35 bitop3:0xc8
    v_cmp_ne_u32 s[50:51], 0, v5
    s_waitcnt vmcnt(6)
    v_xor_b32 v36, s8, v36
    v_xor_b32 v37, s9, v37
    v_xor_b32 v38, s12, v38
    v_xor_b32 v39, s13, v39
    v_or3_b32 v5, v36, v37, v38
    v_bitop3_b32 v5, v5, v15, v39 bitop3:0xc8
    v_cmp_ne_u32 s[52:53], 0, v5
    s_waitcnt vmcnt(5)
    v_xor_b32 v40, s8, v40
    v_xor_b32 v41, s9, v41
    v_xor_b32 v42, s12, v42
    v_xor_b32 v43, s13, v43
    v_or3_b32 v5, v40, v41, v42
    v_bitop3_b32 v5, v5, v15, v43 bitop3:0xc8
    v_cmp_ne_u32 s[56:57], 0, v5
    s_waitcnt vmcnt(4)
    v_xor_b32 v44, s8, v44
    v_xor_b32 v45, s9, v45
    v_xor_b32 v46, s12, v46
    v_xor_b32 v47, s13, v47
    v_or3_b32 v5, v44, v45, v46
    v_bitop3_b32 v5, v5, v15, v47 bitop3:0xc8
    v_cmp_ne_u32 s[58:59], 0, v5
    s_waitcnt vmcnt(3)
    v_xor_b32 v48, s8, v48
    v_xor_b32 v49, s9, v49
    v_xor_b32 v50, s12, v50
    v_xor_b32 v51, s13, v51
    v_or3_b32 v5, v48, v49, v50
    v_bitop3_b32 v5, v5, v15, v51 bitop3:0xc8
    v_cmp_ne_u32 s[60:61], 0, v5
    s_waitcnt vmcnt(2)
    v_xor_b32 v52, s8, v52
    v_xor_b32 v53, s9, v53
    v_xor_b32 v54, s12, v54
    v_xor_b32 v55, s13, v55
    v_or3_b32 v5, v52, v53, v54
    v_bitop3_b32 v5, v5, v15, v55 bitop3:0xc8
    v_cmp_ne_u32 s[62:63], 0, v5
    s_waitcnt vmcnt(1)
    v_xor_b32 v56, s8, v56
    v_xor_b32 v57, s9, v57
    v_xor_b32 v58, s12, v58
    v_xor_b32 v59, s13, v59
    v_or3_b32 v5, v56, v57, v58
    v_bitop3_b32 v5, v5, v15, v59 bitop3:0xc8
    v_cmp_ne_u32 s[64:65], 0, v5
    s_waitcnt vmcnt(0)
    v_xor_b32 v60, s8, v60
    v_xor_b32 v61, s9, v61
    v_xor_b32 v62, s12, v62
    v_xor_b32 v63, s13, v63
    v_or3_b32 v5, v60, v61, v62
    v_bitop3_b32 v5, v5, v15, v63 bitop3:0xc8
    v_cmp_ne_u32 s[66:67], 0, v5
MG_1:
    s_or_b64 vcc, s[50:51], s[52:53]
    s_or_b64 vcc, vcc, s[56:57]
    s_or_b64 vcc, vcc, s[58:59]
    s_or_b64 vcc, vcc, s[60:61]
    s_or_b64 vcc, vcc, s[62:63]
    s_or_b64 vcc, vcc, s[64:65]
    s_or_b64 vcc, vcc, s[66:67]
    s_cbranch_scc0 MGD_2
MI_3:
    s_wqm_b64 exec, s[50:51]
    s_cbranch_execz MS_4
    buffer_load_dwordx4 v[32:35], v1, s[44:47], s40 offen offset:0 sc1
MS_4:
    s_wqm_b64 exec, s[52:53]
    s_cbranch_execz MS_5
    buffer_load_dwordx4 v[36:39], v1, s[44:47], s40 offen offset:1024 sc1
MS_5:
    s_wqm_b64 exec, s[56:57]
    s_cbranch_execz MS_6
    buffer_load_dwordx4 v[40:43], v1, s[44:47], s40 offen offset:2048 sc1
MS_6:
    s_wqm_b64 exec, s[58:59]
    s_cbranch_execz MS_7
    buffer_load_dwordx4 v[44:47], v1, s[44:47], s40 offen offset:3072 sc1
MS_7:
    s_wqm_b64 exec, s[60:61]
    s_cbranch_execz MS_8
    buffer_load_dwordx4 v[48:51], v1, s[44:47], s41 offen offset:0 sc1
MS_8:
    s_wqm_b64 exec, s[62:63]
    s_cbranch_execz MS_9
    buffer_load_dwordx4 v[52:55], v1, s[44:47], s41 offen offset:1024 sc1
MS_9:
    s_wqm_b64 exec, s[64:65]
    s_cbranch_execz MS_10
    buffer_load_dwordx4 v[56:59], v1, s[44:47], s41 offen offset:2048 sc1
MS_10:
    s_wqm_b64 exec, s[66:67]
    s_cbranch_execz MS_11
    buffer_load_dwordx4 v[60:63], v1, s[44:47], s41 offen offset:3072 sc1
MS_11:
    s_waitcnt vmcnt(0)
    s_wqm_b64 exec, s[50:51]
    s_cbranch_execz MC_12
    v_xor_b32 v32, s8, v32
    v_xor_b32 v33, s9, v33
    v_xor_b32 v34, s12, v34
    v_xor_b32 v35, s13, v35
    v_or3_b32 v5, v32, v33, v34
    v_bitop3_b32 v5, v5, v15, v35 bitop3:0xc8
    v_cmp_ne_u32 s[50:51], 0, v5
MC_12:
    s_wqm_b64 exec, s[52:53]
    s_cbranch_execz MC_13
    v_xor_b32 v36, s8, v36
    v_xor_b32 v37, s9, v37
    v_xor_b32 v38, s12, v38
    v_xor_b32 v39, s13, v39
    v_or3_b32 v5, v36, v37, v38
    v_bitop3_b32 v5, v5, v15, v39 bitop3:0xc8
    v_cmp_ne_u32 s[52:53], 0, v5
MC_13:
    s_wqm_b64 exec, s[56:57]
    s_cbranch_execz MC_14
    v_xor_b32 v40, s8, v40
    v_xor_b32 v41, s9, v41
    v_xor_b32 v42, s12, v42
    v_xor_b32 v43, s13, v43
    v_or3_b32 v5, v40, v41, v42
    v_bitop3_b32 v5, v5, v15, v43 bitop3:0xc8
    v_cmp_ne_u32 s[56:57], 0, v5
MC_14:
    s_wqm_b64 exec, s[58:59]
    s_cbranch_execz MC_15
    v_xor_b32 v44, s8, v44
    v_xor_b32 v45, s9, v45
    v_xor_b32 v46, s12, v46
    v_xor_b32 v47, s13, v47
    v_or3_b32 v5, v44, v45, v46
    v_bitop3_b32 v5, v5, v15, v47 bitop3:0xc8
    v_cmp_ne_u32 s[58:59], 0, v5
MC_15:
    s_wqm_b64 exec, s[60:61]
    s_cbranch_execz MC_16
    v_xor_b32 v48, s8, v48
    v_xor_b32 v49, s9, v49
    v_xor_b32 v50, s12, v50
    v_xor_b32 v51, s13, v51
    v_or3_b32 v5, v48, v49, v50
    v_bitop3_b32 v5, v5, v15, v51 bitop3:0xc8
    v_cmp_ne_u32 s[60:61], 0, v5
MC_16:
    s_wqm_b64 exec, s[62:63]
    s_cbranch_execz MC_17
    v_xor_b32 v52, s8, v52
    v_xor_b32 v53, s9, v53
    v_xor_b32 v54, s12, v54
    v_xor_b32 v55, s13, v55
    v_or3_b32 v5, v52, v53, v54
    v_bitop3_b32 v5, v5, v15, v55 bitop3:0xc8
    v_cmp_ne_u32 s[62:63], 0, v5
MC_17:
    s_wqm_b64 exec, s[64:65]
    s_cbranch_execz MC_18
    v_xor_b32 v56, s8, v56
    v_xor_b32 v57, s9, v57
    v_xor_b32 v58, s12, v58
    v_xor_b32 v59, s13, v59
    v_or3_b32 v5, v56, v57, v58
    v_bitop3_b32 v5, v5, v15, v59 bitop3:0xc8
    v_cmp_ne_u32 s[64:65], 0, v5
MC_18:
    s_wqm_b64 exec, s[66:67]
    s_cbranch_execz MC_19
    v_xor_b32 v60, s8, v60
    v_xor_b32 v61, s9, v61
    v_xor_b32 v62, s12, v62
    v_xor_b32 v63, s13, v63
    v_or3_b32 v5, v60, v61, v62
    v_bitop3_b32 v5, v5, v15, v63 bitop3:0xc8
    v_cmp_ne_u32 s[66:67], 0, v5
MC_19:
    s_mov_b64 exec, -1
    s_sub_u32 s49, s49, 1
    s_cbranch_scc0 MG_1
MGD_2:
    v_add_f32 v32, v32, v48
    v_add_f32 v33, v33, v49
    v_add_f32 v34, v34, v50
    v_add_f32 v35, v35, v51
    v_cvt_pk_bf16_f32 v32, v32, v33
    v_cvt_pk_bf16_f32 v33, v34, v35
    ds_write_b64 v8, v[32:33] offset:34816
    v_add_f32 v36, v36, v52
    v_add_f32 v37, v37, v53
    v_add_f32 v38, v38, v54
    v_add_f32 v39, v39, v55
    v_cvt_pk_bf16_f32 v36, v36, v37
    v_cvt_pk_bf16_f32 v37, v38, v39
    ds_write_b64 v8, v[36:37] offset:35360
    v_add_f32 v40, v40, v56
    v_add_f32 v41, v41, v57
    v_add_f32 v42, v42, v58
    v_add_f32 v43, v43, v59
    v_cvt_pk_bf16_f32 v40, v40, v41
    v_cvt_pk_bf16_f32 v41, v42, v43
    ds_write_b64 v8, v[40:41] offset:35904
    v_add_f32 v44, v44, v60
    v_add_f32 v45, v45, v61
    v_add_f32 v46, v46, v62
    v_add_f32 v47, v47, v63
    v_cvt_pk_bf16_f32 v44, v44, v45
    v_cvt_pk_bf16_f32 v45, v46, v47
    ds_write_b64 v8, v[44:45] offset:36448
    ds_write_b32 v9, v6 offset:39568
    s_setprio 2
L_nq:
    s_mul_i32 s48, s17, 96
    v_mov_b32 v15, s48
    s_lshl_b32 s48, s17, 5
    v_add_u32 v13, s48, v10
    s_mov_b32 s49, 0x40000
W_20:
    ds_read_b32 v5, v15 offset:39568
    s_waitcnt lgkmcnt(0)
    v_readfirstlane_b32 s48, v5
    s_cmp_ge_u32 s48, 1
    s_cbranch_scc1 D_21
    s_sleep 1
    s_sub_u32 s49, s49, 1
    s_cbranch_scc0 W_20
D_21:
    ds_read_b128 v[16:19], v3 offset:34816
    ds_read_b128 v[20:23], v3 offset:34944
    s_waitcnt lgkmcnt(0)
    s_waitcnt vmcnt(0)
    v_mfma_f32_16x16x32_bf16 v[32:35], v[64:67], v[16:19], 0
    v_mfma_f32_16x16x32_bf16 v[36:39], v[72:75], v[16:19], 0
    v_mfma_f32_16x16x32_bf16 v[40:43], v[80:83], v[16:19], 0
    v_mfma_f32_16x16x32_bf16 v[44:47], v[88:91], v[16:19], 0
    v_mfma_f32_16x16x32_bf16 v[48:51], v[96:99], v[16:19], 0
    v_mfma_f32_16x16x32_bf16 v[52:55], v[104:107], v[16:19], 0
    v_mfma_f32_16x16x32_bf16 v[56:59], v[112:115], v[16:19], 0
    v_mfma_f32_16x16x32_bf16 v[60:63], v[120:123], v[16:19], 0
    v_mfma_f32_16x16x32_bf16 v[32:35], v[68:71], v[20:23], v[32:35]
    v_mfma_f32_16x16x32_bf16 v[36:39], v[76:79], v[20:23], v[36:39]
    v_mfma_f32_16x16x32_bf16 v[40:43], v[84:87], v[20:23], v[40:43]
    v_mfma_f32_16x16x32_bf16 v[44:47], v[92:95], v[20:23], v[44:47]
    v_mfma_f32_16x16x32_bf16 v[48:51], v[100:103], v[20:23], v[48:51]
    v_mfma_f32_16x16x32_bf16 v[52:55], v[108:111], v[20:23], v[52:55]
    v_mfma_f32_16x16x32_bf16 v[56:59], v[116:119], v[20:23], v[56:59]
    v_mfma_f32_16x16x32_bf16 v[60:63], v[124:127], v[20:23], v[60:63]
    s_nop 0
    v_cndmask_b32 v32, v35, v32, s[14:15]
    v_cndmask_b32 v33, v33, v34, s[14:15]
    v_cndmask_b32 v36, v39, v36, s[14:15]
    v_cndmask_b32 v37, v37, v38, s[14:15]
    v_cndmask_b32 v40, v43, v40, s[14:15]
    v_cndmask_b32 v41, v41, v42, s[14:15]
    v_cndmask_b32 v44, v47, v44, s[14:15]
    v_cndmask_b32 v45, v45, v46, s[14:15]
    v_cndmask_b32 v48, v51, v48, s[14:15]
    v_cndmask_b32 v49, v49, v50, s[14:15]
    v_cndmask_b32 v52, v55, v52, s[14:15]
    v_cndmask_b32 v53, v53, v54, s[14:15]
    v_cndmask_b32 v56, v59, v56, s[14:15]
    v_cndmask_b32 v57, v57, v58, s[14:15]
    v_cndmask_b32 v60, v63, v60, s[14:15]
    v_cndmask_b32 v61, v61, v62, s[14:15]
    v_add_f32_dpp v24, v33, v32 row_ror:8 row_mask:0xf bank_mask:0xf
    v_add_f32_dpp v25, v37, v36 row_ror:8 row_mask:0xf bank_mask:0xf
    v_add_f32_dpp v26, v41, v40 row_ror:8 row_mask:0xf bank_mask:0xf
    v_add_f32_dpp v27, v45, v44 row_ror:8 row_mask:0xf bank_mask:0xf
    v_add_f32_dpp v28, v49, v48 row_ror:8 row_mask:0xf bank_mask:0xf
    v_add_f32_dpp v29, v53, v52 row_ror:8 row_mask:0xf bank_mask:0xf
    v_add_f32_dpp v30, v57, v56 row_ror:8 row_mask:0xf bank_mask:0xf
    v_add_f32_dpp v31, v61, v60 row_ror:8 row_mask:0xf bank_mask:0xf
    v_cvt_pk_bf16_f32 v32, v24, v25
    v_cvt_pk_bf16_f32 v33, v26, v27
    v_cvt_pk_bf16_f32 v34, v28, v29
    v_cvt_pk_bf16_f32 v35, v30, v31
    v_lshlrev_b32 v24, 16, v32
    v_and_b32 v25, s100, v32
    v_lshlrev_b32 v26, 16, v33
    v_and_b32 v27, s100, v33
    v_lshlrev_b32 v28, 16, v34
    v_and_b32 v29, s100, v34
    v_lshlrev_b32 v30, 16, v35
    v_and_b32 v31, s100, v35
    v_mul_f32 v24, s101, v24
    v_mul_f32 v25, s101, v25
    v_mul_f32 v26, s101, v26
    v_mul_f32 v27, s101, v27
    v_mul_f32 v28, s101, v28
    v_mul_f32 v29, s101, v29
    v_mul_f32 v30, s101, v30
    v_mul_f32 v31, s101, v31
    v_cvt_pk_bf16_f32 v32, v24, v25
    v_cvt_pk_bf16_f32 v33, v26, v27
    v_cvt_pk_bf16_f32 v34, v28, v29
    v_cvt_pk_bf16_f32 v35, v30, v31
    v_lshlrev_b32 v24, 16, v32
    v_and_b32 v25, s100, v32
    v_lshlrev_b32 v26, 16, v33
    v_and_b32 v27, s100, v33
    v_lshlrev_b32 v28, 16, v34
    v_and_b32 v29, s100, v34
    v_lshlrev_b32 v30, 16, v35
    v_and_b32 v31, s100, v35
    v_max3_f32 v8, v24, v25, v26
    v_max3_f32 v9, v27, v28, v29
    v_max3_f32 v8, v8, v30, v31
    v_max_f32 v8, v8, v9
    s_nop 1
    v_max_f32_dpp v8, v8, v8 row_ror:8 row_mask:0xf bank_mask:0xf
    v_mov_b32 v9, v8
    s_nop 1
    v_permlane16_swap_b32 v8, v9
    s_nop 1
    v_max_f32 v8, v8, v9
    v_mov_b32 v9, v8
    s_nop 1
    v_permlane32_swap_b32 v8, v9
    s_nop 1
    v_max_f32 v8, v8, v9
    s_mov_b64 exec, 0xff
    ds_max_f32 v13, v8 offset:39424
    s_mov_b64 exec, 1
    ds_add_u32 v15, v6 offset:39556
    s_mov_b64 exec, -1
    s_cmp_ge_u32 s3, 8
    s_cbranch_scc1 L_young
    s_setprio 1
    buffer_load_dwordx4 v[64:67], v1, s[36:39], s96 offen offset:0 nt
    s_nop 0
    buffer_load_dwordx4 v[68:71], v1, s[36:39], s96 offen offset:1024 nt
    s_nop 0
    buffer_load_dwordx4 v[96:99], v1, s[36:39], s96 offen offset:2048 nt
    s_nop 0
    buffer_load_dwordx4 v[100:103], v1, s[36:39], s96 offen offset:3072 nt
    s_nop 0
    buffer_load_dwordx4 v[72:75], v1, s[36:39], s97 offen offset:0 nt
    s_nop 0
    buffer_load_dwordx4 v[76:79], v1, s[36:39], s97 offen offset:1024 nt
    s_nop 0
    buffer_load_dwordx4 v[104:107], v1, s[36:39], s97 offen offset:2048 nt
    s_nop 0
    buffer_load_dwordx4 v[108:111], v1, s[36:39], s97 offen offset:3072 nt
    s_nop 0
    buffer_load_dwordx4 v[80:83], v1, s[36:39], s98 offen offset:0 nt
    s_nop 0
    buffer_load_dwordx4 v[84:87], v1, s[36:39], s98 offen offset:1024 nt
    s_nop 0
    buffer_load_dwordx4 v[112:115], v1, s[36:39], s98 offen offset:2048 nt
    s_nop 0
    buffer_load_dwordx4 v[116:119], v1, s[36:39], s98 offen offset:3072 nt
    s_nop 0
    buffer_load_dwordx4 v[88:91], v1, s[36:39], s99 offen offset:0 nt
    s_nop 0
    buffer_load_dwordx4 v[92:95], v1, s[36:39], s99 offen offset:1024 nt
    s_nop 0
    buffer_load_dwordx4 v[120:123], v1, s[36:39], s99 offen offset:2048 nt
    s_nop 0
    buffer_load_dwordx4 v[124:127], v1, s[36:39], s99 offen offset:3072 nt
    s_nop 0
    s_setprio 2
L_young:
    s_mov_b32 s49, 0x40000
W_22:
    ds_read_b32 v5, v15 offset:39556
    s_waitcnt lgkmcnt(0)
    v_readfirstlane_b32 s48, v5
    s_cmp_ge_u32 s48, s18
    s_cbranch_scc1 D_23
    s_sleep 1
    s_sub_u32 s49, s49, 1
    s_cbranch_scc0 W_22
D_23:
    ds_read_b32 v12, v13 offset:39424
    s_waitcnt lgkmcnt(0)
    v_sub_f32 v24, v24, v12
    v_sub_f32 v25, v25, v12
    v_sub_f32 v26, v26, v12
    v_sub_f32 v27, v27, v12
    v_sub_f32 v28, v28, v12
    v_sub_f32 v29, v29, v12
    v_sub_f32 v30, v30, v12
    v_sub_f32 v31, v31, v12
    v_mul_f32 v24, 0x3fb8aa3b, v24
    v_mul_f32 v25, 0x3fb8aa3b, v25
    v_mul_f32 v26, 0x3fb8aa3b, v26
    v_mul_f32 v27, 0x3fb8aa3b, v27
    v_mul_f32 v28, 0x3fb8aa3b, v28
    v_mul_f32 v29, 0x3fb8aa3b, v29
    v_mul_f32 v30, 0x3fb8aa3b, v30
    v_mul_f32 v31, 0x3fb8aa3b, v31
    v_exp_f32 v24, v24
    v_exp_f32 v25, v25
    v_exp_f32 v26, v26
    v_exp_f32 v27, v27
    v_exp_f32 v28, v28
    v_exp_f32 v29, v29
    v_exp_f32 v30, v30
    v_exp_f32 v31, v31
    s_nop 0
    v_cvt_pk_bf16_f32 v32, v24, v25
    v_cvt_pk_bf16_f32 v33, v26, v27
    v_cvt_pk_bf16_f32 v34, v28, v29
    v_cvt_pk_bf16_f32 v35, v30, v31
    v_add_f32 v14, v24, v25
    v_add_f32 v9, v26, v27
    v_add_f32 v14, v14, v28
    v_add_f32 v9, v9, v29
    v_add_f32 v14, v14, v30
    v_add_f32 v9, v9, v31
    v_add_f32 v14, v14, v9
    s_nop 1
    v_add_f32_dpp v14, v14, v14 row_ror:8 row_mask:0xf bank_mask:0xf
    v_mov_b32 v9, v14
    s_nop 1
    v_permlane16_swap_b32 v14, v9
    s_nop 1
    v_add_f32 v14, v14, v9
    v_mov_b32 v9, v14
    s_nop 1
    v_permlane32_swap_b32 v14, v9
    s_nop 1
    v_add_f32 v14, v14, v9
    s_mov_b64 exec, 0xff
    ds_add_f32 v13, v14 offset:39488
    s_mov_b64 exec, 1
    ds_add_u32 v15, v6 offset:39564
    s_mov_b64 exec, -1
    v_cndmask_b32 v16, 0, v32, s[14:15]
    v_cndmask_b32 v17, 0, v33, s[14:15]
    v_cndmask_b32 v18, 0, v34, s[14:15]
    v_cndmask_b32 v19, 0, v35, s[14:15]
    v_cndmask_b32 v28, v32, 0, s[14:15]
    v_cndmask_b32 v29, v33, 0, s[14:15]
    v_cndmask_b32 v30, v34, 0, s[14:15]
    v_cndmask_b32 v31, v35, 0, s[14:15]
    v_mov_b32_dpp v24, v16 row_ror:8 row_mask:0xf bank_mask:0xf
    v_mov_b32_dpp v25, v17 row_ror:8 row_mask:0xf bank_mask:0xf
    v_mov_b32_dpp v26, v18 row_ror:8 row_mask:0xf bank_mask:0xf
    v_mov_b32_dpp v27, v19 row_ror:8 row_mask:0xf bank_mask:0xf
    v_mov_b32_dpp v20, v28 row_ror:8 row_mask:0xf bank_mask:0xf
    v_mov_b32_dpp v21, v29 row_ror:8 row_mask:0xf bank_mask:0xf
    v_mov_b32_dpp v22, v30 row_ror:8 row_mask:0xf bank_mask:0xf
    v_mov_b32_dpp v23, v31 row_ror:8 row_mask:0xf bank_mask:0xf
    v_lshrrev_b32 v57, 10, v11
    v_mov_b32 v32, 0
    v_mov_b32 v33, 0
    v_mov_b32 v34, 0
    v_mov_b32 v35, 0
    v_mov_b32 v36, 0
    v_mov_b32 v37, 0
    v_mov_b32 v38, 0
    v_mov_b32 v39, 0
    v_mov_b32 v40, 0
    v_mov_b32 v41, 0
    v_mov_b32 v42, 0
    v_mov_b32 v43, 0
    v_mov_b32 v44, 0
    v_mov_b32 v45, 0
    v_mov_b32 v46, 0
    v_mov_b32 v47, 0
    s_lshr_b32 s52, s3, 2
    s_sub_u32 s52, s52, s16
    s_max_i32 s52, s52, 0
    s_cmp_lt_u32 s3, 8
    s_cbranch_scc1 L_old
    s_setprio 1
    buffer_load_dwordx4 v[64:67], v1, s[36:39], s96 offen offset:0 nt
    s_nop 0
    buffer_load_dwordx4 v[68:71], v1, s[36:39], s96 offen offset:1024 nt
    s_nop 0
    buffer_load_dwordx4 v[96:99], v1, s[36:39], s96 offen offset:2048 nt
    s_nop 0
    buffer_load_dwordx4 v[100:103], v1, s[36:39], s96 offen offset:3072 nt
    s_nop 0
    buffer_load_dwordx4 v[72:75], v1, s[36:39], s97 offen offset:0 nt
    s_nop 0
    buffer_load_dwordx4 v[76:79], v1, s[36:39], s97 offen offset:1024 nt
    s_nop 0
    buffer_load_dwordx4 v[104:107], v1, s[36:39], s97 offen offset:2048 nt
    s_nop 0
    buffer_load_dwordx4 v[108:111], v1, s[36:39], s97 offen offset:3072 nt
    s_nop 0
    buffer_load_dwordx4 v[80:83], v1, s[36:39], s98 offen offset:0 nt
    s_nop 0
    buffer_load_dwordx4 v[84:87], v1, s[36:39], s98 offen offset:1024 nt
    s_nop 0
    buffer_load_dwordx4 v[112:115], v1, s[36:39], s98 offen offset:2048 nt
    s_nop 0
    buffer_load_dwordx4 v[116:119], v1, s[36:39], s98 offen offset:3072 nt
    s_nop 0
    ds_write_b32 v4, v6 offset:39572
    buffer_load_dwordx4 v[88:91], v1, s[36:39], s99 offen offset:0 nt
    s_nop 0
    buffer_load_dwordx4 v[92:95], v1, s[36:39], s99 offen offset:1024 nt
    s_nop 0
    buffer_load_dwordx4 v[120:123], v1, s[36:39], s99 offen offset:2048 nt
    s_nop 0
    buffer_load_dwordx4 v[124:127], v1, s[36:39], s99 offen offset:3072 nt
    s_nop 0
    s_setprio 2
L_old:
    s_cmp_eq_u32 s52, 0
    s_cbranch_scc1 L_noch
    s_mov_b32 s49, 0x40000
W_24:
    ds_read_b32 v5, v57 offset:39600
    s_waitcnt lgkmcnt(0)
    v_readfirstlane_b32 s48, v5
    s_cmp_ge_u32 s48, s52
    s_cbranch_scc1 D_25
    s_sleep 1
    s_sub_u32 s49, s49, 1
    s_cbranch_scc0 W_24
D_25:
    ds_read_b128 v[32:35], v11 offset:0
    ds_read_b128 v[36:39], v11 offset:1024
    ds_read_b128 v[40:43], v11 offset:2048
    ds_read_b128 v[44:47], v11 offset:3072
L_noch:
    s_waitcnt lgkmcnt(0)
    s_waitcnt vmcnt(2)
    v_perm_b32 v48, v68, v64, s30
    v_perm_b32 v49, v76, v72, s30
    v_perm_b32 v50, v84, v80, s30
    v_perm_b32 v51, v92, v88, s30
    v_perm_b32 v52, v68, v64, s31
    v_perm_b32 v53, v76, v72, s31
    v_perm_b32 v54, v84, v80, s31
    v_perm_b32 v55, v92, v88, s31
    v_mfma_f32_16x16x32_bf16 v[32:35], v[48:51], v[16:19], v[32:35]
    v_perm_b32 v48, v69, v65, s30
    v_perm_b32 v49, v77, v73, s30
    v_perm_b32 v50, v85, v81, s30
    v_perm_b32 v51, v93, v89, s30
    v_mfma_f32_16x16x32_bf16 v[36:39], v[52:55], v[16:19], v[36:39]
    v_perm_b32 v52, v69, v65, s31
    v_perm_b32 v53, v77, v73, s31
    v_perm_b32 v54, v85, v81, s31
    v_perm_b32 v55, v93, v89, s31
    v_mfma_f32_16x16x32_bf16 v[40:43], v[48:51], v[16:19], v[40:43]
    v_perm_b32 v48, v70, v66, s30
    v_perm_b32 v49, v78, v74, s30
    v_perm_b32 v50, v86, v82, s30
    v_perm_b32 v51, v94, v90, s30
    v_mfma_f32_16x16x32_bf16 v[44:47], v[52:55], v[16:19], v[44:47]
    v_perm_b32 v52, v70, v66, s31
    v_perm_b32 v53, v78, v74, s31
    v_perm_b32 v54, v86, v82, s31
    v_perm_b32 v55, v94, v90, s31
    v_mfma_f32_16x16x32_bf16 v[32:35], v[48:51], v[24:27], v[32:35]
    v_perm_b32 v48, v71, v67, s30
    v_perm_b32 v49, v79, v75, s30
    v_perm_b32 v50, v87, v83, s30
    v_perm_b32 v51, v95, v91, s30
    v_mfma_f32_16x16x32_bf16 v[36:39], v[52:55], v[24:27], v[36:39]
    v_perm_b32 v52, v71, v67, s31
    v_perm_b32 v53, v79, v75, s31
    v_perm_b32 v54, v87, v83, s31
    v_perm_b32 v55, v95, v91, s31
    v_mfma_f32_16x16x32_bf16 v[40:43], v[48:51], v[24:27], v[40:43]
    s_nop 1
    v_mfma_f32_16x16x32_bf16 v[44:47], v[52:55], v[24:27], v[44:47]
    s_waitcnt vmcnt(0)
    v_perm_b32 v48, v100, v96, s30
    v_perm_b32 v49, v108, v104, s30
    v_perm_b32 v50, v116, v112, s30
    v_perm_b32 v51, v124, v120, s30
    v_perm_b32 v52, v100, v96, s31
    v_perm_b32 v53, v108, v104, s31
    v_perm_b32 v54, v116, v112, s31
    v_perm_b32 v55, v124, v120, s31
    v_mfma_f32_16x16x32_bf16 v[32:35], v[48:51], v[20:23], v[32:35]
    v_perm_b32 v48, v101, v97, s30
    v_perm_b32 v49, v109, v105, s30
    v_perm_b32 v50, v117, v113, s30
    v_perm_b32 v51, v125, v121, s30
    v_mfma_f32_16x16x32_bf16 v[36:39], v[52:55], v[20:23], v[36:39]
    v_perm_b32 v52, v101, v97, s31
    v_perm_b32 v53, v109, v105, s31
    v_perm_b32 v54, v117, v113, s31
    v_perm_b32 v55, v125, v121, s31
    v_mfma_f32_16x16x32_bf16 v[40:43], v[48:51], v[20:23], v[40:43]
    v_perm_b32 v48, v102, v98, s30
    v_perm_b32 v49, v110, v106, s30
    v_perm_b32 v50, v118, v114, s30
    v_perm_b32 v51, v126, v122, s30
    v_mfma_f32_16x16x32_bf16 v[44:47], v[52:55], v[20:23], v[44:47]
    v_perm_b32 v52, v102, v98, s31
    v_perm_b32 v53, v110, v106, s31
    v_perm_b32 v54, v118, v114, s31
    v_perm_b32 v55, v126, v122, s31
    v_mfma_f32_16x16x32_bf16 v[32:35], v[48:51], v[28:31], v[32:35]
    v_perm_b32 v48, v103, v99, s30
    v_perm_b32 v49, v111, v107, s30
    v_perm_b32 v50, v119, v115, s30
    v_perm_b32 v51, v127, v123, s30
    v_mfma_f32_16x16x32_bf16 v[36:39], v[52:55], v[28:31], v[36:39]
    v_perm_b32 v52, v103, v99, s31
    v_perm_b32 v53, v111, v107, s31
    v_perm_b32 v54, v119, v115, s31
    v_perm_b32 v55, v127, v123, s31
    v_mfma_f32_16x16x32_bf16 v[40:43], v[48:51], v[28:31], v[40:43]
    s_nop 1
    v_mfma_f32_16x16x32_bf16 v[44:47], v[52:55], v[28:31], v[44:47]
    s_nop 5
    s_cmp_lg_u32 s17, 0
    s_cbranch_scc1 L_wfin
    ds_write_b128 v11, v[32:35] offset:0
    ds_write_b128 v11, v[36:39] offset:1024
    ds_write_b128 v11, v[40:43] offset:2048
    ds_write_b128 v11, v[44:47] offset:3072
    s_mov_b64 exec, 1
    ds_add_u32 v57, v6 offset:39600
    s_mov_b64 exec, -1
    s_branch L_tdone
L_wfin:
    ds_write_b128 v11, v[32:35] offset:16384
    ds_write_b128 v11, v[36:39] offset:17408
    ds_write_b128 v11, v[40:43] offset:18432
    ds_write_b128 v11, v[44:47] offset:19456
    s_mov_b64 exec, 1
    ds_add_u32 v4, v6 offset:39672
    s_mov_b64 exec, -1
    v_lshl_add_u32 v59, v57, 8, v1
    v_lshrrev_b32 v58, 3, v0
    v_mul_u32_u24 v58, 8448, v58
    v_lshl_add_u32 v58, v10, 2, v58
    v_mov_b32 v56, 0xffffff00
    s_sub_u32 s50, s19, s23
    s_lshl_b32 s50, s50, 7
    s_add_u32 s51, s50, s5
    s_add_u32 s51, s51, 135168
    s_add_u32 s50, s50, s6
    s_mul_i32 s52, s3, 67584
    s_add_u32 s50, s50, s52
    s_add_u32 s50, s50, 1081344
    s_mov_b32 s49, 0x40000
W_26:
    ds_read_b32 v5, v4 offset:39672
    s_waitcnt lgkmcnt(0)
    v_readfirstlane_b32 s48, v5
    s_cmp_ge_u32 s48, 4
    s_cbranch_scc1 D_27
    s_sleep 1
    s_sub_u32 s49, s49, 1
    s_cbranch_scc0 W_26
D_27:
    ds_read_b128 v[64:67], v59 offset:16384
    ds_read_b128 v[68:71], v59 offset:20480
    ds_read_b128 v[72:75], v59 offset:24576
    ds_read_b128 v[76:79], v59 offset:28672
    ds_read_b32 v14, v13 offset:39488
    s_waitcnt lgkmcnt(0)
    v_mov_b32 v13, s55
    v_mov_b32 v15, s55
    v_add_f32 v32, v64, v68
    v_add_f32 v33, v65, v69
    v_add_f32 v34, v66, v70
    v_add_f32 v35, v67, v71
    v_add_f32 v36, v72, v76
    v_add_f32 v37, v73, v77
    v_add_f32 v38, v74, v78
    v_add_f32 v39, v75, v79
    v_add_f32 v32, v32, v36
    v_add_f32 v33, v33, v37
    v_add_f32 v34, v34, v38
    v_add_f32 v35, v35, v39
    v_and_or_b32 v32, v32, v56, s8
    v_and_or_b32 v33, v33, v56, s9
    v_and_or_b32 v34, v34, v56, s12
    v_and_or_b32 v35, v35, v56, s13
    s_setprio 3
    buffer_store_dwordx4 v[32:35], v58, s[44:47], s50 offen sc1
    s_cmp_lg_u32 s3, 1
    s_cbranch_scc1 L_wnm
    s_mov_b64 exec, 0xffff
    buffer_store_dwordx4 v[12:15], v58, s[44:47], s51 offen sc1
    s_mov_b64 exec, -1
L_wnm:
    s_setprio 2
L_tdone:
    s_cmp_ge_u32 s3, 8
    s_cbranch_scc1 L_c
    s_cmp_lg_u32 s3, 0
    s_cbranch_scc1 L_wo
    s_lshr_b32 s53, s2, 5
    s_lshl_b32 s53, s53, 8
    s_add_u32 s53, s53, 4096
    s_lshl_b32 s57, s22, 8
    s_lshl_b32 s48, s0, 7
    s_add_u32 s57, s57, s48
    s_sub_u32 s62, s1, 32
    s_mov_b32 s52, 4
    s_setprio 3
    s_mov_b32 s49, 0x40000
W_28:
    ds_read_b32 v5, v4 offset:39572
    s_waitcnt lgkmcnt(0)
    v_readfirstlane_b32 s48, v5
    s_cmp_ge_u32 s48, 1
    s_cbranch_scc1 D_29
    s_sleep 2
    s_sub_u32 s49, s49, 1
    s_cbranch_scc0 W_28
D_29:
L_deal:
    s_mov_b32 s51, 0x8000
L_drt:
    s_mov_b32 s66, 1
    s_mov_b32 s67, 0
    s_atomic_add_x2 s[66:67], s[28:29], s53 glc
    s_waitcnt lgkmcnt(0)
    s_cmp_eq_u32 s67, s55
    s_cbranch_scc1 L_dok
    s_sub_u32 s51, s51, 1
    s_cbranch_scc0 L_drt
    s_mov_b32 s66, 0x10000
L_dok:
    s_cmp_lt_u32 s66, 64
    s_cselect_b32 s58, s57, s62
    s_add_u32 s58, s58, s66
    s_add_u32 s58, s58, 1
    s_cmp_lt_u32 s66, 160
    s_cselect_b32 s58, s58, 0x10000
    s_mul_i32 s59, s20, 0
    s_sub_u32 s59, s66, s59
    s_cmp_ge_i32 s59, 184
    s_cselect_b32 s48, 1, 2
    s_cmp_ge_i32 s59, 174
    s_cselect_b32 s48, s48, 3
    v_mov_b32 v8, s58
    v_mov_b32 v9, s52
    v_mov_b32 v5, s48
    ds_write_b32 v4, v5 offset:39580
    ds_write_b32 v9, v8 offset:40192
    s_cmp_ge_u32 s66, 160
    s_cbranch_scc1 L_ddone
    s_add_u32 s52, s52, 4
    s_add_u32 s59, s52, 2
    s_cmp_ge_u32 s66, 96
    s_cselect_b32 s58, s59, s52
    s_mov_b32 s49, 0x40000
W_30:
    ds_read_b32 v5, v4 offset:39592
    s_waitcnt lgkmcnt(0)
    v_readfirstlane_b32 s48, v5
    s_cmp_ge_u32 s48, s58
    s_cbranch_scc1 D_31
    s_sub_u32 s49, s49, 1
    s_cbranch_scc0 W_30
D_31:
    s_branch L_deal
L_ddone:
    s_setprio 2
L_wo:
    s_mov_b32 s40, s10
    s_mov_b32 s41, s11
    s_lshr_b32 s50, s4, 4
    s_lshl_b32 s50, s50, 10
    s_and_b32 s51, s4, 3
    s_lshl_b32 s51, s51, 5
    s_add_u32 s50, s50, s51
    s_bfe_u32 s51, s4, 0x20002
    s_add_u32 s50, s50, s51
    s_lshl_b32 s50, s50, 11
    s_lshl_b32 s51, s7, 10
    s_add_u32 s50, s50, s51
    s_lshl_b32 s51, s3, 7
    s_add_u32 s50, s50, s51
    v_lshrrev_b32 v8, 4, v0
    v_and_b32 v61, 8, v0
    v_lshlrev_b32 v58, 19, v8
    v_lshl_add_u32 v58, v10, 2, v58
    v_lshl_add_u32 v58, v61, 10, v58
    v_mov_b32 v56, 0xffffff00
    v_and_b32 v60, 1, v0
    v_lshlrev_b32 v60, 6, v60
    v_lshl_add_u32 v60, v8, 4, v60
    v_bfe_u32 v59, v0, 2, 1
    v_mul_u32_u24 v59, 8448, v59
    v_and_b32 v7, 3, v0
    v_lshl_add_u32 v59, v7, 5, v59
    v_lshl_add_u32 v59, v61, 1, v59
    s_lshl_b32 s53, s20, 5
    s_lshl_b32 s48, s7, 4
    s_add_u32 s53, s53, s48
    s_lshl_b32 s48, s3, 1
    s_add_u32 s53, s53, s48
    s_mul_i32 s53, s53, 8448
    s_lshl_b32 s48, s4, 7
    s_add_u32 s53, s53, s48
    s_add_u32 s53, s53, 2883584
    s_mov_b32 s49, 0x40000
W_32:
    ds_read_b32 v5, v57 offset:39616
    s_waitcnt lgkmcnt(0)
    v_readfirstlane_b32 s48, v5
    s_cmp_ge_u32 s48, 1
    s_cbranch_scc1 D_33
    s_sleep 1
    s_sub_u32 s49, s49, 1
    s_cbranch_scc0 W_32
D_33:
    ds_read_b32 v5, v4 offset:39580
    s_waitcnt lgkmcnt(0)
    v_readfirstlane_b32 s52, v5
    s_mov_b32 s49, 0x40000
W_34:
    ds_read_b32 v5, v57 offset:39616
    s_waitcnt lgkmcnt(0)
    v_readfirstlane_b32 s48, v5
    s_cmp_ge_u32 s48, s52
    s_cbranch_scc1 D_35
    s_sleep 1
    s_sub_u32 s49, s49, 1
    s_cbranch_scc0 W_34
D_35:
    s_setprio 0
    buffer_load_dwordx4 v[64:67], v58, s[40:43], s50 offen nt
    s_add_u32 s50, s50, 16384
    buffer_load_dwordx4 v[68:71], v58, s[40:43], s50 offen nt
    s_add_u32 s50, s50, 16384
    buffer_load_dwordx4 v[72:75], v58, s[40:43], s50 offen nt
    s_add_u32 s50, s50, 16384
    buffer_load_dwordx4 v[76:79], v58, s[40:43], s50 offen nt
    s_add_u32 s50, s50, 212992
    buffer_load_dwordx4 v[80:83], v58, s[40:43], s50 offen nt
    s_add_u32 s50, s50, 16384
    buffer_load_dwordx4 v[84:87], v58, s[40:43], s50 offen nt
    s_add_u32 s50, s50, 16384
    buffer_load_dwordx4 v[88:91], v58, s[40:43], s50 offen nt
    s_add_u32 s50, s50, 16384
    buffer_load_dwordx4 v[92:95], v58, s[40:43], s50 offen nt
    s_setprio 2
    s_waitcnt vmcnt(0)
    s_mov_b64 exec, 1
    ds_add_u32 v4, v6 offset:39588
    s_mov_b64 exec, -1
    v_perm_b32 v96, v68, v64, s30
    v_perm_b32 v97, v76, v72, s30
    v_perm_b32 v98, v84, v80, s30
    v_perm_b32 v99, v92, v88, s30
    v_perm_b32 v100, v68, v64, s31
    v_perm_b32 v101, v76, v72, s31
    v_perm_b32 v102, v84, v80, s31
    v_perm_b32 v103, v92, v88, s31
    v_perm_b32 v104, v69, v65, s30
    v_perm_b32 v105, v77, v73, s30
    v_perm_b32 v106, v85, v81, s30
    v_perm_b32 v107, v93, v89, s30
    v_perm_b32 v108, v69, v65, s31
    v_perm_b32 v109, v77, v73, s31
    v_perm_b32 v110, v85, v81, s31
    v_perm_b32 v111, v93, v89, s31
    v_perm_b32 v112, v70, v66, s30
    v_perm_b32 v113, v78, v74, s30
    v_perm_b32 v114, v86, v82, s30
    v_perm_b32 v115, v94, v90, s30
    v_perm_b32 v116, v70, v66, s31
    v_perm_b32 v117, v78, v74, s31
    v_perm_b32 v118, v86, v82, s31
    v_perm_b32 v119, v94, v90, s31
    v_perm_b32 v120, v71, v67, s30
    v_perm_b32 v121, v79, v75, s30
    v_perm_b32 v122, v87, v83, s30
    v_perm_b32 v123, v95, v91, s30
    v_perm_b32 v124, v71, v67, s31
    v_perm_b32 v125, v79, v75, s31
    v_perm_b32 v126, v87, v83, s31
    v_perm_b32 v127, v95, v91, s31
    s_mov_b32 s49, 0x40000
L_ow:
    ds_read_b32 v5, v4 offset:39576
    ds_read_b128 v[16:19], v60 offset:39680
    s_waitcnt lgkmcnt(0)
    v_readfirstlane_b32 s48, v5
    s_cmp_ge_u32 s48, 2
    s_cbranch_scc1 L_owd
    s_sub_u32 s49, s49, 1
    s_cbranch_scc0 L_ow
L_owd:
    v_mfma_f32_16x16x32_bf16 v[24:27], v[16:19], v[96:99], 0
    v_mfma_f32_16x16x32_bf16 v[40:43], v[16:19], v[112:115], 0
    v_mfma_f32_16x16x32_bf16 v[28:31], v[16:19], v[100:103], 0
    v_mfma_f32_16x16x32_bf16 v[44:47], v[16:19], v[116:119], 0
    v_mfma_f32_16x16x32_bf16 v[32:35], v[16:19], v[104:107], 0
    v_mfma_f32_16x16x32_bf16 v[48:51], v[16:19], v[120:123], 0
    v_mfma_f32_16x16x32_bf16 v[36:39], v[16:19], v[108:111], 0
    v_mfma_f32_16x16x32_bf16 v[52:55], v[16:19], v[124:127], 0
    s_nop 1
    v_cndmask_b32 v26, v41, v24, s[14:15]
    v_cndmask_b32 v27, v25, v40, s[14:15]
    v_cndmask_b32 v30, v45, v28, s[14:15]
    v_cndmask_b32 v31, v29, v44, s[14:15]
    v_cndmask_b32 v34, v49, v32, s[14:15]
    v_cndmask_b32 v35, v33, v48, s[14:15]
    v_cndmask_b32 v38, v53, v36, s[14:15]
    v_cndmask_b32 v39, v37, v52, s[14:15]
    s_mov_b64 exec, 0xffff
    v_add_f32_dpp v20, v27, v26 row_ror:8 row_mask:0xf bank_mask:0xf
    v_add_f32_dpp v21, v31, v30 row_ror:8 row_mask:0xf bank_mask:0xf
    v_add_f32_dpp v22, v35, v34 row_ror:8 row_mask:0xf bank_mask:0xf
    v_add_f32_dpp v23, v39, v38 row_ror:8 row_mask:0xf bank_mask:0xf
    v_and_or_b32 v20, v20, v56, s8
    v_and_or_b32 v21, v21, v56, s9
    v_and_or_b32 v22, v22, v56, s12
    v_and_or_b32 v23, v23, v56, s13
    buffer_store_dwordx4 v[20:23], v59, s[44:47], s53 offen sc1
    s_mov_b64 exec, -1
    s_branch L_fin
L_dyn:
    s_sub_u32 s52, s3, 12
    s_cmp_lg_u32 s52, 0
    s_cbranch_scc1 L_nopre
    s_and_b32 s48, s23, 31
    s_add_u32 s48, s48, s1
    s_add_u32 s48, s48, 1
    v_mov_b32 v8, s48
    ds_write_b32 v4, v8 offset:40192
L_nopre:
    s_mul_i32 s27, s52, 12288
    s_add_u32 s27, s27, 42240
    v_add_u32 v63, s27, v1
    v_mov_b32 v32, 0
    v_mov_b32 v33, 0
    v_mov_b32 v34, 0
    v_mov_b32 v35, 0
    v_mov_b32 v36, 0
    v_mov_b32 v37, 0
    v_mov_b32 v38, 0
    v_mov_b32 v39, 0
    v_mov_b32 v40, 0
    v_mov_b32 v41, 0
    v_mov_b32 v42, 0
    v_mov_b32 v43, 0
    v_mov_b32 v44, 0
    v_mov_b32 v45, 0
    v_mov_b32 v46, 0
    v_mov_b32 v47, 0
    v_mov_b32 v12, 0xf149f2ca
    v_mov_b32 v14, 0
    v_lshrrev_b32 v57, 10, v11
    v_mov_b32 v56, 0xffffff00
    v_lshrrev_b32 v58, 3, v0
    v_mul_u32_u24 v58, 8448, v58
    v_lshl_add_u32 v58, v10, 2, v58
    v_lshl_add_u32 v59, v57, 8, v1
    v_lshlrev_b32 v61, 3, v10
    v_lshl_add_u32 v60, v57, 1, v61
    v_mov_b32 v62, 0
    v_mov_b32 v7, 0x3fb8aa3b
    s_lshl_b32 s26, s22, 24
    s_lshl_b32 s48, s52, 12
    s_add_u32 s26, s26, s48
    s_sub_u32 s26, s26, 16384
    s_mul_i32 s56, s52, 67584
    v_mov_b32 v13, s55
    v_mov_b32 v15, s55
    s_and_b32 s48, s23, 31
    s_or_b32 s48, s48, s52
    s_cbranch_scc1 L_ni
    v_mov_b32 v8, 32
    v_mov_b32 v9, s55
    s_lshr_b32 s48, s2, 5
    s_lshl_b32 s48, s48, 8
    s_add_u32 s48, s48, 4096
    s_mov_b64 exec, 1
    s_setprio 3
    buffer_store_dwordx2 v[8:9], v4, s[44:47], s48 offen sc1
    s_setprio 2
    s_mov_b64 exec, -1
L_ni:
    s_sub_u32 s57, 3, s16
    s_add_u32 s56, s56, s6
    s_mov_b32 s21, 0
    s_mov_b32 s64, 0
    s_mov_b32 s65, 0
    s_mov_b32 s60, 0
    s_mov_b32 s59, 0
L_dl:
    s_cmp_lg_u32 s65, 0
    s_cbranch_scc1 DR_38
    ds_read_b32 v5, v62 offset:40192
    s_waitcnt lgkmcnt(0)
    v_readfirstlane_b32 s48, v5
    s_cmp_eq_u32 s48, 0
    s_cbranch_scc1 NO_41
TK_40:
    v_add_u32 v62, 4, v62
    s_sub_u32 s49, s48, 1
    s_cmp_ge_u32 s49, 1024
    s_cbranch_scc1 EX_37
    s_lshl_b32 s50, s48, 14
    s_add_u32 s50, s50, s26
    s_add_u32 s48, s27, 0
    s_mov_b64 exec, 1
    ds_max_u32 v4, v62 offset:39592
    s_mov_b64 exec, -1
    s_mov_b32 m0, s48
    s_add_u32 s48, s48, 896
    buffer_load_dwordx4 v2, s[32:35], s50 offen offset:0 nt lds
    s_mov_b32 m0, s48
    s_add_u32 s48, s48, 128
    buffer_load_dwordx4 v2, s[32:35], s50 offen offset:128 nt lds
    s_mov_b32 m0, s48
    s_add_u32 s48, s48, 896
    buffer_load_dwordx4 v2, s[32:35], s50 offen offset:1024 nt lds
    s_mov_b32 m0, s48
    s_add_u32 s48, s48, 0
    buffer_load_dwordx4 v2, s[32:35], s50 offen offset:1152 nt lds
    v_add_u32 v5, 2, v62
    buffer_load_dwordx4 v[80:83], v1, s[36:39], s50 offen offset:0 nt
    s_nop 0
    buffer_load_dwordx4 v[84:87], v1, s[36:39], s50 offen offset:1024 nt
    s_nop 0
    buffer_load_dwordx4 v[88:91], v1, s[36:39], s50 offen offset:2048 nt
    s_nop 0
    s_mov_b64 exec, 1
    ds_max_u32 v4, v5 offset:39592
    s_mov_b64 exec, -1
    buffer_load_dwordx4 v[92:95], v1, s[36:39], s50 offen offset:3072 nt
    s_nop 0
    s_setprio 1
    s_add_u32 s64, s64, 1
    s_mov_b32 s61, 0
    s_cmp_eq_u32 s60, 0
    s_mov_b32 s60, 0
    s_cbranch_scc1 PR_36
    s_branch NX_39
NO_41:
    s_mov_b32 s61, 1
    s_mov_b32 s60, 1
    s_branch PR_36
EX_37:
    s_getpc_b64 s[62:63]
    s_branch L_exh
    s_mov_b32 s65, s60
    s_cmp_lg_u32 s60, 0
    s_mov_b32 s60, 0
    s_cbranch_scc1 NX_39
DR_38:
    s_add_u32 s65, s65, 1
    v_mov_b32 v5, s65
    ds_write_b32 v57, v5 offset:39616
    s_cmp_gt_u32 s65, 2
    s_cbranch_scc1 L_dfin
    s_mov_b32 s61, s65
PR_36:
    s_cmp_lt_u32 s21, 2
    s_cbranch_scc1 PE_42
    s_waitcnt vmcnt(20)
    s_cmp_eq_u32 s61, 0
    s_cbranch_scc1 WT_44
    s_waitcnt vmcnt(12)
    s_cmp_eq_u32 s61, 1
    s_cbranch_scc1 WT_44
    s_waitcnt vmcnt(4)
WT_44:
    ds_read_b128 v[64:67], v63 offset:4096
    ds_read_b128 v[68:71], v63 offset:5120
    ds_read_b128 v[72:75], v63 offset:6144
    ds_read_b128 v[76:79], v63 offset:7168
    s_waitcnt lgkmcnt(0)
    v_mfma_f32_16x16x32_bf16 v[48:51], v[64:67], v[16:19], 0
    v_mfma_f32_16x16x32_bf16 v[52:55], v[72:75], v[16:19], 0
    v_mfma_f32_16x16x32_bf16 v[48:51], v[68:71], v[20:23], v[48:51]
    v_mfma_f32_16x16x32_bf16 v[52:55], v[76:79], v[20:23], v[52:55]
    s_nop 6
    v_cndmask_b32 v48, v51, v48, s[14:15]
    v_cndmask_b32 v49, v49, v50, s[14:15]
    v_cndmask_b32 v52, v55, v52, s[14:15]
    v_cndmask_b32 v53, v53, v54, s[14:15]
    s_nop 1
    v_add_f32_dpp v24, v49, v48 row_ror:8 row_mask:0xf bank_mask:0xf
    v_add_f32_dpp v25, v53, v52 row_ror:8 row_mask:0xf bank_mask:0xf
    v_cvt_pk_bf16_f32 v26, v24, v25
    v_lshlrev_b32 v24, 16, v26
    v_and_b32 v25, s100, v26
    v_mul_f32 v24, s101, v24
    v_mul_f32 v25, s101, v25
    v_cvt_pk_bf16_f32 v26, v24, v25
    v_lshlrev_b32 v24, 16, v26
    v_and_b32 v25, s100, v26
    v_max3_f32 v8, v24, v25, v12
    s_nop 1
    v_max_f32_dpp v8, v8, v8 row_ror:8 row_mask:0xf bank_mask:0xf
    v_mov_b32 v9, v8
    s_nop 1
    v_permlane16_swap_b32 v8, v9
    s_nop 1
    v_max_f32 v8, v8, v9
    v_mov_b32 v9, v8
    s_nop 1
    v_permlane32_swap_b32 v8, v9
    s_nop 1
    v_max_f32 v8, v8, v9
    v_sub_f32 v9, v12, v8
    v_sub_f32 v24, v24, v8
    v_sub_f32 v25, v25, v8
    v_mul_f32 v9, v7, v9
    v_mul_f32 v24, v7, v24
    v_mul_f32 v25, v7, v25
    v_exp_f32 v9, v9
    v_exp_f32 v24, v24
    v_exp_f32 v25, v25
    v_mov_b32 v12, v8
    v_cvt_pk_bf16_f32 v26, v24, v25
    v_fma_f32 v14, v14, v9, v24
    v_add_f32 v14, v14, v25
    v_mov_b32_dpp v27, v26 row_ror:8 row_mask:0xf bank_mask:0xf
    v_mul_f32 v32, v32, v9
    v_mul_f32 v33, v33, v9
    v_mul_f32 v34, v34, v9
    v_mul_f32 v35, v35, v9
    v_mul_f32 v36, v36, v9
    v_mul_f32 v37, v37, v9
    v_mul_f32 v38, v38, v9
    v_mul_f32 v39, v39, v9
    v_mul_f32 v40, v40, v9
    v_mul_f32 v41, v41, v9
    v_mul_f32 v42, v42, v9
    v_mul_f32 v43, v43, v9
    v_mul_f32 v44, v44, v9
    v_mul_f32 v45, v45, v9
    v_mul_f32 v46, v46, v9
    v_mul_f32 v47, v47, v9
    v_cndmask_b32 v28, 0, v26, s[14:15]
    v_cndmask_b32 v29, 0, v27, s[14:15]
    v_cndmask_b32 v30, v27, 0, s[14:15]
    v_cndmask_b32 v31, v26, 0, s[14:15]
    s_waitcnt vmcnt(16)
    s_cmp_eq_u32 s61, 0
    s_cbranch_scc1 WT_45
    s_waitcnt vmcnt(8)
    s_cmp_eq_u32 s61, 1
    s_cbranch_scc1 WT_45
    s_waitcnt vmcnt(0)
WT_45:
    v_perm_b32 v64, v100, v96, s30
    v_perm_b32 v65, v108, v104, s30
    v_perm_b32 v66, v100, v96, s31
    v_perm_b32 v67, v108, v104, s31
    v_perm_b32 v68, v101, v97, s30
    v_perm_b32 v69, v109, v105, s30
    v_perm_b32 v70, v101, v97, s31
    v_perm_b32 v71, v109, v105, s31
    v_perm_b32 v72, v102, v98, s30
    v_perm_b32 v73, v110, v106, s30
    v_perm_b32 v74, v102, v98, s31
    v_perm_b32 v75, v110, v106, s31
    v_perm_b32 v76, v103, v99, s30
    v_perm_b32 v77, v111, v107, s30
    v_perm_b32 v78, v103, v99, s31
    v_perm_b32 v79, v111, v107, s31
    v_mfma_f32_16x16x16_bf16 v[32:35], v[64:65], v[28:29], v[32:35]
    v_mfma_f32_16x16x16_bf16 v[36:39], v[66:67], v[28:29], v[36:39]
    v_mfma_f32_16x16x16_bf16 v[40:43], v[68:69], v[28:29], v[40:43]
    v_mfma_f32_16x16x16_bf16 v[44:47], v[70:71], v[28:29], v[44:47]
    v_mfma_f32_16x16x16_bf16 v[32:35], v[72:73], v[30:31], v[32:35]
    v_mfma_f32_16x16x16_bf16 v[36:39], v[74:75], v[30:31], v[36:39]
    v_mfma_f32_16x16x16_bf16 v[40:43], v[76:77], v[30:31], v[40:43]
    v_mfma_f32_16x16x16_bf16 v[44:47], v[78:79], v[30:31], v[44:47]
PE_42:
    s_cmp_eq_u32 s60, 0
    s_cbranch_scc1 NX_39
    s_getpc_b64 s[62:63]
    s_branch L_tryf
    s_mov_b32 s49, 0x40000
W_46:
    ds_read_b32 v5, v62 offset:40192
    s_waitcnt lgkmcnt(0)
    v_readfirstlane_b32 s48, v5
    s_cmp_ge_u32 s48, 1
    s_cbranch_scc1 D_47
    s_sleep 1
    s_sub_u32 s49, s49, 1
    s_cbranch_scc0 W_46
D_47:
    s_branch TK_40
NX_39:
    s_add_u32 s21, s21, 1
    s_cmp_lg_u32 s65, 0
    s_cbranch_scc1 DR_50
    ds_read_b32 v5, v62 offset:40192
    s_waitcnt lgkmcnt(0)
    v_readfirstlane_b32 s48, v5
    s_cmp_eq_u32 s48, 0
    s_cbranch_scc1 NO_53
TK_52:
    v_add_u32 v62, 4, v62
    s_sub_u32 s49, s48, 1
    s_cmp_ge_u32 s49, 1024
    s_cbranch_scc1 EX_49
    s_lshl_b32 s50, s48, 14
    s_add_u32 s50, s50, s26
    s_add_u32 s48, s27, 4096
    s_mov_b64 exec, 1
    ds_max_u32 v4, v62 offset:39592
    s_mov_b64 exec, -1
    s_mov_b32 m0, s48
    s_add_u32 s48, s48, 896
    buffer_load_dwordx4 v2, s[32:35], s50 offen offset:0 nt lds
    s_mov_b32 m0, s48
    s_add_u32 s48, s48, 128
    buffer_load_dwordx4 v2, s[32:35], s50 offen offset:128 nt lds
    s_mov_b32 m0, s48
    s_add_u32 s48, s48, 896
    buffer_load_dwordx4 v2, s[32:35], s50 offen offset:1024 nt lds
    s_mov_b32 m0, s48
    s_add_u32 s48, s48, 0
    buffer_load_dwordx4 v2, s[32:35], s50 offen offset:1152 nt lds
    v_add_u32 v5, 2, v62
    buffer_load_dwordx4 v[96:99], v1, s[36:39], s50 offen offset:0 nt
    s_nop 0
    buffer_load_dwordx4 v[100:103], v1, s[36:39], s50 offen offset:1024 nt
    s_nop 0
    buffer_load_dwordx4 v[104:107], v1, s[36:39], s50 offen offset:2048 nt
    s_nop 0
    s_mov_b64 exec, 1
    ds_max_u32 v4, v5 offset:39592
    s_mov_b64 exec, -1
    buffer_load_dwordx4 v[108:111], v1, s[36:39], s50 offen offset:3072 nt
    s_nop 0
    s_setprio 1
    s_add_u32 s64, s64, 1
    s_mov_b32 s61, 0
    s_cmp_eq_u32 s60, 0
    s_mov_b32 s60, 0
    s_cbranch_scc1 PR_48
    s_branch NX_51
NO_53:
    s_mov_b32 s61, 1
    s_mov_b32 s60, 1
    s_branch PR_48
EX_49:
    s_getpc_b64 s[62:63]
    s_branch L_exh
    s_mov_b32 s65, s60
    s_cmp_lg_u32 s60, 0
    s_mov_b32 s60, 0
    s_cbranch_scc1 NX_51
DR_50:
    s_add_u32 s65, s65, 1
    v_mov_b32 v5, s65
    ds_write_b32 v57, v5 offset:39616
    s_cmp_gt_u32 s65, 2
    s_cbranch_scc1 L_dfin
    s_mov_b32 s61, s65
PR_48:
    s_cmp_lt_u32 s21, 2
    s_cbranch_scc1 PE_54
    s_waitcnt vmcnt(20)
    s_cmp_eq_u32 s61, 0
    s_cbranch_scc1 WT_56
    s_waitcnt vmcnt(12)
    s_cmp_eq_u32 s61, 1
    s_cbranch_scc1 WT_56
    s_waitcnt vmcnt(4)
WT_56:
    ds_read_b128 v[64:67], v63 offset:8192
    ds_read_b128 v[68:71], v63 offset:9216
    ds_read_b128 v[72:75], v63 offset:10240
    ds_read_b128 v[76:79], v63 offset:11264
    s_waitcnt lgkmcnt(0)
    v_mfma_f32_16x16x32_bf16 v[48:51], v[64:67], v[16:19], 0
    v_mfma_f32_16x16x32_bf16 v[52:55], v[72:75], v[16:19], 0
    v_mfma_f32_16x16x32_bf16 v[48:51], v[68:71], v[20:23], v[48:51]
    v_mfma_f32_16x16x32_bf16 v[52:55], v[76:79], v[20:23], v[52:55]
    s_nop 6
    v_cndmask_b32 v48, v51, v48, s[14:15]
    v_cndmask_b32 v49, v49, v50, s[14:15]
    v_cndmask_b32 v52, v55, v52, s[14:15]
    v_cndmask_b32 v53, v53, v54, s[14:15]
    s_nop 1
    v_add_f32_dpp v24, v49, v48 row_ror:8 row_mask:0xf bank_mask:0xf
    v_add_f32_dpp v25, v53, v52 row_ror:8 row_mask:0xf bank_mask:0xf
    v_cvt_pk_bf16_f32 v26, v24, v25
    v_lshlrev_b32 v24, 16, v26
    v_and_b32 v25, s100, v26
    v_mul_f32 v24, s101, v24
    v_mul_f32 v25, s101, v25
    v_cvt_pk_bf16_f32 v26, v24, v25
    v_lshlrev_b32 v24, 16, v26
    v_and_b32 v25, s100, v26
    v_max3_f32 v8, v24, v25, v12
    s_nop 1
    v_max_f32_dpp v8, v8, v8 row_ror:8 row_mask:0xf bank_mask:0xf
    v_mov_b32 v9, v8
    s_nop 1
    v_permlane16_swap_b32 v8, v9
    s_nop 1
    v_max_f32 v8, v8, v9
    v_mov_b32 v9, v8
    s_nop 1
    v_permlane32_swap_b32 v8, v9
    s_nop 1
    v_max_f32 v8, v8, v9
    v_sub_f32 v9, v12, v8
    v_sub_f32 v24, v24, v8
    v_sub_f32 v25, v25, v8
    v_mul_f32 v9, v7, v9
    v_mul_f32 v24, v7, v24
    v_mul_f32 v25, v7, v25
    v_exp_f32 v9, v9
    v_exp_f32 v24, v24
    v_exp_f32 v25, v25
    v_mov_b32 v12, v8
    v_cvt_pk_bf16_f32 v26, v24, v25
    v_fma_f32 v14, v14, v9, v24
    v_add_f32 v14, v14, v25
    v_mov_b32_dpp v27, v26 row_ror:8 row_mask:0xf bank_mask:0xf
    v_mul_f32 v32, v32, v9
    v_mul_f32 v33, v33, v9
    v_mul_f32 v34, v34, v9
    v_mul_f32 v35, v35, v9
    v_mul_f32 v36, v36, v9
    v_mul_f32 v37, v37, v9
    v_mul_f32 v38, v38, v9
    v_mul_f32 v39, v39, v9
    v_mul_f32 v40, v40, v9
    v_mul_f32 v41, v41, v9
    v_mul_f32 v42, v42, v9
    v_mul_f32 v43, v43, v9
    v_mul_f32 v44, v44, v9
    v_mul_f32 v45, v45, v9
    v_mul_f32 v46, v46, v9
    v_mul_f32 v47, v47, v9
    v_cndmask_b32 v28, 0, v26, s[14:15]
    v_cndmask_b32 v29, 0, v27, s[14:15]
    v_cndmask_b32 v30, v27, 0, s[14:15]
    v_cndmask_b32 v31, v26, 0, s[14:15]
    s_waitcnt vmcnt(16)
    s_cmp_eq_u32 s61, 0
    s_cbranch_scc1 WT_57
    s_waitcnt vmcnt(8)
    s_cmp_eq_u32 s61, 1
    s_cbranch_scc1 WT_57
    s_waitcnt vmcnt(0)
WT_57:
    v_perm_b32 v64, v116, v112, s30
    v_perm_b32 v65, v124, v120, s30
    v_perm_b32 v66, v116, v112, s31
    v_perm_b32 v67, v124, v120, s31
    v_perm_b32 v68, v117, v113, s30
    v_perm_b32 v69, v125, v121, s30
    v_perm_b32 v70, v117, v113, s31
    v_perm_b32 v71, v125, v121, s31
    v_perm_b32 v72, v118, v114, s30
    v_perm_b32 v73, v126, v122, s30
    v_perm_b32 v74, v118, v114, s31
    v_perm_b32 v75, v126, v122, s31
    v_perm_b32 v76, v119, v115, s30
    v_perm_b32 v77, v127, v123, s30
    v_perm_b32 v78, v119, v115, s31
    v_perm_b32 v79, v127, v123, s31
    v_mfma_f32_16x16x16_bf16 v[32:35], v[64:65], v[28:29], v[32:35]
    v_mfma_f32_16x16x16_bf16 v[36:39], v[66:67], v[28:29], v[36:39]
    v_mfma_f32_16x16x16_bf16 v[40:43], v[68:69], v[28:29], v[40:43]
    v_mfma_f32_16x16x16_bf16 v[44:47], v[70:71], v[28:29], v[44:47]
    v_mfma_f32_16x16x16_bf16 v[32:35], v[72:73], v[30:31], v[32:35]
    v_mfma_f32_16x16x16_bf16 v[36:39], v[74:75], v[30:31], v[36:39]
    v_mfma_f32_16x16x16_bf16 v[40:43], v[76:77], v[30:31], v[40:43]
    v_mfma_f32_16x16x16_bf16 v[44:47], v[78:79], v[30:31], v[44:47]
PE_54:
    s_cmp_eq_u32 s60, 0
    s_cbranch_scc1 NX_51
    s_getpc_b64 s[62:63]
    s_branch L_tryf
    s_mov_b32 s49, 0x40000
W_58:
    ds_read_b32 v5, v62 offset:40192
    s_waitcnt lgkmcnt(0)
    v_readfirstlane_b32 s48, v5
    s_cmp_ge_u32 s48, 1
    s_cbranch_scc1 D_59
    s_sleep 1
    s_sub_u32 s49, s49, 1
    s_cbranch_scc0 W_58
D_59:
    s_branch TK_52
NX_51:
    s_add_u32 s21, s21, 1
    s_cmp_lg_u32 s65, 0
    s_cbranch_scc1 DR_62
    ds_read_b32 v5, v62 offset:40192
    s_waitcnt lgkmcnt(0)
    v_readfirstlane_b32 s48, v5
    s_cmp_eq_u32 s48, 0
    s_cbranch_scc1 NO_65
TK_64:
    v_add_u32 v62, 4, v62
    s_sub_u32 s49, s48, 1
    s_cmp_ge_u32 s49, 1024
    s_cbranch_scc1 EX_61
    s_lshl_b32 s50, s48, 14
    s_add_u32 s50, s50, s26
    s_add_u32 s48, s27, 8192
    s_mov_b64 exec, 1
    ds_max_u32 v4, v62 offset:39592
    s_mov_b64 exec, -1
    s_mov_b32 m0, s48
    s_add_u32 s48, s48, 896
    buffer_load_dwordx4 v2, s[32:35], s50 offen offset:0 nt lds
    s_mov_b32 m0, s48
    s_add_u32 s48, s48, 128
    buffer_load_dwordx4 v2, s[32:35], s50 offen offset:128 nt lds
    s_mov_b32 m0, s48
    s_add_u32 s48, s48, 896
    buffer_load_dwordx4 v2, s[32:35], s50 offen offset:1024 nt lds
    s_mov_b32 m0, s48
    s_add_u32 s48, s48, 0
    buffer_load_dwordx4 v2, s[32:35], s50 offen offset:1152 nt lds
    v_add_u32 v5, 2, v62
    buffer_load_dwordx4 v[112:115], v1, s[36:39], s50 offen offset:0 nt
    s_nop 0
    buffer_load_dwordx4 v[116:119], v1, s[36:39], s50 offen offset:1024 nt
    s_nop 0
    buffer_load_dwordx4 v[120:123], v1, s[36:39], s50 offen offset:2048 nt
    s_nop 0
    s_mov_b64 exec, 1
    ds_max_u32 v4, v5 offset:39592
    s_mov_b64 exec, -1
    buffer_load_dwordx4 v[124:127], v1, s[36:39], s50 offen offset:3072 nt
    s_nop 0
    s_setprio 1
    s_add_u32 s64, s64, 1
    s_mov_b32 s61, 0
    s_cmp_eq_u32 s60, 0
    s_mov_b32 s60, 0
    s_cbranch_scc1 PR_60
    s_branch NX_63
NO_65:
    s_mov_b32 s61, 1
    s_mov_b32 s60, 1
    s_branch PR_60
EX_61:
    s_getpc_b64 s[62:63]
    s_branch L_exh
    s_mov_b32 s65, s60
    s_cmp_lg_u32 s60, 0
    s_mov_b32 s60, 0
    s_cbranch_scc1 NX_63
DR_62:
    s_add_u32 s65, s65, 1
    v_mov_b32 v5, s65
    ds_write_b32 v57, v5 offset:39616
    s_cmp_gt_u32 s65, 2
    s_cbranch_scc1 L_dfin
    s_mov_b32 s61, s65
PR_60:
    s_cmp_lt_u32 s21, 2
    s_cbranch_scc1 PE_66
    s_cmp_lg_u32 s21, 2
    s_cbranch_scc1 NF_67
    s_mov_b32 s49, 0x40000
W_68:
    ds_read_b32 v5, v4 offset:39568
    s_waitcnt lgkmcnt(0)
    v_readfirstlane_b32 s48, v5
    s_cmp_ge_u32 s48, 1
    s_cbranch_scc1 D_69
    s_sleep 1
    s_sub_u32 s49, s49, 1
    s_cbranch_scc0 W_68
D_69:
    ds_read_b128 v[16:19], v3 offset:34816
    ds_read_b128 v[20:23], v3 offset:34944
    s_waitcnt lgkmcnt(0)
NF_67:
    s_waitcnt vmcnt(20)
    s_cmp_eq_u32 s61, 0
    s_cbranch_scc1 WT_70
    s_waitcnt vmcnt(12)
    s_cmp_eq_u32 s61, 1
    s_cbranch_scc1 WT_70
    s_waitcnt vmcnt(4)
WT_70:
    ds_read_b128 v[64:67], v63 offset:0
    ds_read_b128 v[68:71], v63 offset:1024
    ds_read_b128 v[72:75], v63 offset:2048
    ds_read_b128 v[76:79], v63 offset:3072
    s_waitcnt lgkmcnt(0)
    v_mfma_f32_16x16x32_bf16 v[48:51], v[64:67], v[16:19], 0
    v_mfma_f32_16x16x32_bf16 v[52:55], v[72:75], v[16:19], 0
    v_mfma_f32_16x16x32_bf16 v[48:51], v[68:71], v[20:23], v[48:51]
    v_mfma_f32_16x16x32_bf16 v[52:55], v[76:79], v[20:23], v[52:55]
    s_nop 6
    v_cndmask_b32 v48, v51, v48, s[14:15]
    v_cndmask_b32 v49, v49, v50, s[14:15]
    v_cndmask_b32 v52, v55, v52, s[14:15]
    v_cndmask_b32 v53, v53, v54, s[14:15]
    s_nop 1
    v_add_f32_dpp v24, v49, v48 row_ror:8 row_mask:0xf bank_mask:0xf
    v_add_f32_dpp v25, v53, v52 row_ror:8 row_mask:0xf bank_mask:0xf
    v_cvt_pk_bf16_f32 v26, v24, v25
    v_lshlrev_b32 v24, 16, v26
    v_and_b32 v25, s100, v26
    v_mul_f32 v24, s101, v24
    v_mul_f32 v25, s101, v25
    v_cvt_pk_bf16_f32 v26, v24, v25
    v_lshlrev_b32 v24, 16, v26
    v_and_b32 v25, s100, v26
    v_max3_f32 v8, v24, v25, v12
    s_nop 1
    v_max_f32_dpp v8, v8, v8 row_ror:8 row_mask:0xf bank_mask:0xf
    v_mov_b32 v9, v8
    s_nop 1
    v_permlane16_swap_b32 v8, v9
    s_nop 1
    v_max_f32 v8, v8, v9
    v_mov_b32 v9, v8
    s_nop 1
    v_permlane32_swap_b32 v8, v9
    s_nop 1
    v_max_f32 v8, v8, v9
    v_sub_f32 v9, v12, v8
    v_sub_f32 v24, v24, v8
    v_sub_f32 v25, v25, v8
    v_mul_f32 v9, v7, v9
    v_mul_f32 v24, v7, v24
    v_mul_f32 v25, v7, v25
    v_exp_f32 v9, v9
    v_exp_f32 v24, v24
    v_exp_f32 v25, v25
    v_mov_b32 v12, v8
    v_cvt_pk_bf16_f32 v26, v24, v25
    v_fma_f32 v14, v14, v9, v24
    v_add_f32 v14, v14, v25
    v_mov_b32_dpp v27, v26 row_ror:8 row_mask:0xf bank_mask:0xf
    v_mul_f32 v32, v32, v9
    v_mul_f32 v33, v33, v9
    v_mul_f32 v34, v34, v9
    v_mul_f32 v35, v35, v9
    v_mul_f32 v36, v36, v9
    v_mul_f32 v37, v37, v9
    v_mul_f32 v38, v38, v9
    v_mul_f32 v39, v39, v9
    v_mul_f32 v40, v40, v9
    v_mul_f32 v41, v41, v9
    v_mul_f32 v42, v42, v9
    v_mul_f32 v43, v43, v9
    v_mul_f32 v44, v44, v9
    v_mul_f32 v45, v45, v9
    v_mul_f32 v46, v46, v9
    v_mul_f32 v47, v47, v9
    v_cndmask_b32 v28, 0, v26, s[14:15]
    v_cndmask_b32 v29, 0, v27, s[14:15]
    v_cndmask_b32 v30, v27, 0, s[14:15]
    v_cndmask_b32 v31, v26, 0, s[14:15]
    s_waitcnt vmcnt(16)
    s_cmp_eq_u32 s61, 0
    s_cbranch_scc1 WT_71
    s_waitcnt vmcnt(8)
    s_cmp_eq_u32 s61, 1
    s_cbranch_scc1 WT_71
    s_waitcnt vmcnt(0)
WT_71:
    v_perm_b32 v64, v84, v80, s30
    v_perm_b32 v65, v92, v88, s30
    v_perm_b32 v66, v84, v80, s31
    v_perm_b32 v67, v92, v88, s31
    v_perm_b32 v68, v85, v81, s30
    v_perm_b32 v69, v93, v89, s30
    v_perm_b32 v70, v85, v81, s31
    v_perm_b32 v71, v93, v89, s31
    v_perm_b32 v72, v86, v82, s30
    v_perm_b32 v73, v94, v90, s30
    v_perm_b32 v74, v86, v82, s31
    v_perm_b32 v75, v94, v90, s31
    v_perm_b32 v76, v87, v83, s30
    v_perm_b32 v77, v95, v91, s30
    v_perm_b32 v78, v87, v83, s31
    v_perm_b32 v79, v95, v91, s31
    v_mfma_f32_16x16x16_bf16 v[32:35], v[64:65], v[28:29], v[32:35]
    v_mfma_f32_16x16x16_bf16 v[36:39], v[66:67], v[28:29], v[36:39]
    v_mfma_f32_16x16x16_bf16 v[40:43], v[68:69], v[28:29], v[40:43]
    v_mfma_f32_16x16x16_bf16 v[44:47], v[70:71], v[28:29], v[44:47]
    v_mfma_f32_16x16x16_bf16 v[32:35], v[72:73], v[30:31], v[32:35]
    v_mfma_f32_16x16x16_bf16 v[36:39], v[74:75], v[30:31], v[36:39]
    v_mfma_f32_16x16x16_bf16 v[40:43], v[76:77], v[30:31], v[40:43]
    v_mfma_f32_16x16x16_bf16 v[44:47], v[78:79], v[30:31], v[44:47]
PE_66:
    s_cmp_eq_u32 s60, 0
    s_cbranch_scc1 NX_63
    s_getpc_b64 s[62:63]
    s_branch L_tryf
    s_mov_b32 s49, 0x40000
W_72:
    ds_read_b32 v5, v62 offset:40192
    s_waitcnt lgkmcnt(0)
    v_readfirstlane_b32 s48, v5
    s_cmp_ge_u32 s48, 1
    s_cbranch_scc1 D_73
    s_sleep 1
    s_sub_u32 s49, s49, 1
    s_cbranch_scc0 W_72
D_73:
    s_branch TK_64
NX_63:
    s_add_u32 s21, s21, 1
    s_branch L_dl
L_tryf:
    s_cmp_lg_u32 s59, 0
    s_cbranch_scc1 L_ret
    ds_read_b32 v5, v57 offset:39600
    s_waitcnt lgkmcnt(0)
    v_readfirstlane_b32 s48, v5
    s_cmp_ge_u32 s48, s57
    s_cbranch_scc1 L_fold
    s_branch L_ret
L_exh:
    s_setprio 2
    ds_write_b32 v57, v6 offset:39616
    s_cmp_lg_u32 s59, 0
    s_cbranch_scc1 L_ret
    s_mov_b32 s49, 0x40000
W_74:
    ds_read_b32 v5, v57 offset:39600
    s_waitcnt lgkmcnt(0)
    v_readfirstlane_b32 s48, v5
    s_cmp_ge_u32 s48, s57
    s_cbranch_scc1 D_75
    s_sleep 1
    s_sub_u32 s49, s49, 1
    s_cbranch_scc0 W_74
D_75:
L_fold:
    s_mov_b32 s59, 1
    ds_read_b128 v[64:67], v11 offset:0
    ds_read_b128 v[68:71], v11 offset:1024
    ds_read_b128 v[72:75], v11 offset:2048
    ds_read_b128 v[76:79], v11 offset:3072
    ds_read_b32 v8, v10 offset:39424
    s_mov_b32 s49, 0x40000
W_76:
    ds_read_b32 v5, v4 offset:39564
    s_waitcnt lgkmcnt(0)
    v_readfirstlane_b32 s48, v5
    s_cmp_ge_u32 s48, s18
    s_cbranch_scc1 D_77
    s_sleep 1
    s_sub_u32 s49, s49, 1
    s_cbranch_scc0 W_76
D_77:
    ds_read_b32 v24, v10 offset:39488
    v_max_f32 v25, v8, v12
    v_sub_f32 v9, v12, v25
    v_sub_f32 v8, v8, v25
    v_mul_f32 v9, v7, v9
    v_mul_f32 v8, v7, v8
    v_exp_f32 v9, v9
    v_exp_f32 v8, v8
    v_mov_b32 v12, v25
    s_waitcnt lgkmcnt(0)
    v_mul_f32 v24, 0x3d000000, v24
    v_mul_f32 v14, v14, v9
    v_fmac_f32 v14, v24, v8
    v_mul_f32 v32, v32, v9
    v_mul_f32 v33, v33, v9
    v_mul_f32 v34, v34, v9
    v_mul_f32 v35, v35, v9
    v_mul_f32 v36, v36, v9
    v_mul_f32 v37, v37, v9
    v_mul_f32 v38, v38, v9
    v_mul_f32 v39, v39, v9
    v_mul_f32 v40, v40, v9
    v_mul_f32 v41, v41, v9
    v_mul_f32 v42, v42, v9
    v_mul_f32 v43, v43, v9
    v_mul_f32 v44, v44, v9
    v_mul_f32 v45, v45, v9
    v_mul_f32 v46, v46, v9
    v_mul_f32 v47, v47, v9
    v_fmac_f32 v32, v64, v8
    v_fmac_f32 v33, v65, v8
    v_fmac_f32 v34, v66, v8
    v_fmac_f32 v35, v67, v8
    v_fmac_f32 v36, v68, v8
    v_fmac_f32 v37, v69, v8
    v_fmac_f32 v38, v70, v8
    v_fmac_f32 v39, v71, v8
    v_fmac_f32 v40, v72, v8
    v_fmac_f32 v41, v73, v8
    v_fmac_f32 v42, v74, v8
    v_fmac_f32 v43, v75, v8
    v_fmac_f32 v44, v76, v8
    v_fmac_f32 v45, v77, v8
    v_fmac_f32 v46, v78, v8
    v_fmac_f32 v47, v79, v8
L_ret:
    s_add_u32 s62, s62, 4
    s_addc_u32 s63, s63, 0
    s_setpc_b64 s[62:63]
L_dfin:
    s_setprio 3
    ds_write_b128 v11, v[32:35] offset:0
    ds_write_b128 v11, v[36:39] offset:1024
    ds_write_b128 v11, v[40:43] offset:2048
    ds_write_b128 v11, v[44:47] offset:3072
    v_mov_b32 v24, v12
    v_add_f32_dpp v25, v14, v14 row_ror:8 row_mask:0xf bank_mask:0xf
    v_mov_b32 v9, v25
    s_nop 1
    v_permlane16_swap_b32 v25, v9
    s_nop 1
    v_add_f32 v25, v25, v9
    v_mov_b32 v9, v25
    s_nop 1
    v_permlane32_swap_b32 v25, v9
    s_nop 1
    v_add_f32 v25, v25, v9
    ds_write_b64 v60, v[24:25] offset:39808
    s_mov_b64 exec, 1
    ds_add_u32 v4, v6 offset:39584
    s_mov_b64 exec, -1
    s_mov_b32 s49, 0x40000
L_mw:
    ds_read_b32 v5, v4 offset:39584
    ds_read_b128 v[16:19], v61 offset:39808
    ds_read_b128 v[20:23], v61 offset:39824
    ds_read_b128 v[64:67], v59 offset:0
    ds_read_b128 v[68:71], v59 offset:4096
    ds_read_b128 v[72:75], v59 offset:8192
    ds_read_b128 v[76:79], v59 offset:12288
    s_waitcnt lgkmcnt(6)
    v_readfirstlane_b32 s48, v5
    s_cmp_ge_u32 s48, 4
    s_cbranch_scc1 L_mwd
    s_sub_u32 s49, s49, 1
    s_cbranch_scc0 L_mw
L_mwd:
    s_waitcnt lgkmcnt(4)
    v_max3_f32 v12, v16, v18, v20
    v_max_f32 v12, v12, v22
    v_sub_f32 v16, v16, v12
    v_sub_f32 v18, v18, v12
    v_sub_f32 v20, v20, v12
    v_sub_f32 v22, v22, v12
    v_mul_f32 v16, v7, v16
    v_mul_f32 v18, v7, v18
    v_mul_f32 v20, v7, v20
    v_mul_f32 v22, v7, v22
    v_exp_f32 v16, v16
    v_exp_f32 v18, v18
    v_exp_f32 v20, v20
    v_exp_f32 v22, v22
    s_waitcnt lgkmcnt(0)
    v_mul_f32 v32, v64, v16
    v_mul_f32 v33, v65, v16
    v_mul_f32 v34, v66, v16
    v_mul_f32 v35, v67, v16
    v_fmac_f32 v32, v68, v18
    v_fmac_f32 v33, v69, v18
    v_fmac_f32 v34, v70, v18
    v_fmac_f32 v35, v71, v18
    v_fmac_f32 v32, v72, v20
    v_fmac_f32 v33, v73, v20
    v_fmac_f32 v34, v74, v20
    v_fmac_f32 v35, v75, v20
    v_fmac_f32 v32, v76, v22
    v_fmac_f32 v33, v77, v22
    v_fmac_f32 v34, v78, v22
    v_fmac_f32 v35, v79, v22
    v_and_or_b32 v32, v32, v56, s8
    v_and_or_b32 v33, v33, v56, s9
    v_and_or_b32 v34, v34, v56, s12
    v_and_or_b32 v35, v35, v56, s13
    buffer_store_dwordx4 v[32:35], v58, s[44:47], s56 offen sc1
    s_cmp_lg_u32 s3, 12
    s_cbranch_scc1 L_noml
    v_mul_f32 v14, v17, v16
    v_fmac_f32 v14, v19, v18
    v_fmac_f32 v14, v21, v20
    v_fmac_f32 v14, v23, v22
    s_mov_b64 exec, 0xffff
    buffer_store_dwordx4 v[12:15], v58, s[44:47], s5 offen sc1
    s_mov_b64 exec, -1
L_noml:
    s_mov_b64 exec, 1
    ds_add_u32 v4, v6 offset:39560
    s_mov_b64 exec, -1
    s_branch L_fin
L_c:
    s_cmp_eq_u32 s3, 11
    s_cbranch_scc1 L_red
    s_lshr_b32 s40, s4, 4
    s_lshl_b32 s41, s20, 2
    s_add_u32 s40, s40, s41
    s_cmp_eq_u32 s20, 0
    s_cselect_b32 s53, 8, 0
    s_cmp_lg_u32 s3, 8
    s_cbranch_scc1 L_comb
    s_lshl_b32 s41, s40, 2
    s_and_b32 s42, s2, 1
    s_add_u32 s41, s41, s42
    s_mul_i32 s41, s41, 8448
    s_add_u32 s41, s41, 327680
    s_add_u32 s42, s41, 4096
    v_mov_b32 v14, 0x3fb8aa3b
    v_mov_b32 v96, 0xf149f2ca
    v_mov_b32 v98, 0
    v_mov_b32 v100, 0xf149f2ca
    v_mov_b32 v102, 0
    v_mov_b32 v104, 0xf149f2ca
    v_mov_b32 v106, 0
    v_mov_b32 v108, 0xf149f2ca
    v_mov_b32 v110, 0
    v_mov_b32 v112, 0xf149f2ca
    v_mov_b32 v114, 0
    v_mov_b32 v116, 0xf149f2ca
    v_mov_b32 v118, 0
    v_mov_b32 v120, 0xf149f2ca
    v_mov_b32 v122, 0
    v_mov_b32 v124, 0xf149f2ca
    v_mov_b32 v126, 0
    s_mov_b32 s49, 0x40000
W_78:
    ds_read_b32 v5, v4 offset:39560
    s_waitcnt lgkmcnt(0)
    v_readfirstlane_b32 s48, v5
    s_cmp_ge_u32 s48, 4
    s_cbranch_scc1 D_79
    s_sleep 1
    s_sub_u32 s49, s49, 1
    s_cbranch_scc0 W_78
D_79:
    s_mov_b32 s49, 0x40000
W_80:
    ds_read_b32 v5, v4 offset:39588
    s_waitcnt lgkmcnt(0)
    v_readfirstlane_b32 s48, v5
    s_cmp_ge_u32 s48, s53
    s_cbranch_scc1 D_81
    s_sleep 1
    s_sub_u32 s49, s49, 1
    s_cbranch_scc0 W_80
D_81:
    s_setprio 3
    s_mov_b32 s49, 0x20000
    s_mov_b64 s[50:51], -1
    s_mov_b64 s[52:53], -1
    s_mov_b64 s[56:57], 0
    s_mov_b64 s[58:59], 0
    s_mov_b64 s[60:61], 0
    s_mov_b64 s[62:63], 0
    s_mov_b64 s[64:65], 0
    s_mov_b64 s[66:67], 0
    s_cmp_lg_u32 s20, 0
    s_cbranch_scc1 MI_84
    buffer_load_dwordx4 v[96:99], v1, s[44:47], s41 offen offset:0 sc1
    buffer_load_dwordx4 v[100:103], v1, s[44:47], s41 offen offset:1024 sc1
    buffer_load_dwordx4 v[104:107], v1, s[44:47], s41 offen offset:2048 sc1
    buffer_load_dwordx4 v[108:111], v1, s[44:47], s41 offen offset:3072 sc1
    buffer_load_dwordx4 v[112:115], v1, s[44:47], s42 offen offset:0 sc1
    buffer_load_dwordx4 v[116:119], v1, s[44:47], s42 offen offset:1024 sc1
    buffer_load_dwordx4 v[120:123], v1, s[44:47], s42 offen offset:2048 sc1
    buffer_load_dwordx4 v[124:127], v1, s[44:47], s42 offen offset:3072 sc1
    s_waitcnt vmcnt(7)
    v_xor_b32 v7, s55, v97
    v_bitop3_b32 v7, s55, v7, v99 bitop3:0xde
    v_cmp_ne_u32 s[50:51], 0, v7
    s_waitcnt vmcnt(6)
    v_xor_b32 v7, s55, v101
    v_bitop3_b32 v7, s55, v7, v103 bitop3:0xde
    v_cmp_ne_u32 s[52:53], 0, v7
    s_waitcnt vmcnt(5)
    v_xor_b32 v7, s55, v105
    v_bitop3_b32 v7, s55, v7, v107 bitop3:0xde
    v_cmp_ne_u32 s[56:57], 0, v7
    s_waitcnt vmcnt(4)
    v_xor_b32 v7, s55, v109
    v_bitop3_b32 v7, s55, v7, v111 bitop3:0xde
    v_cmp_ne_u32 s[58:59], 0, v7
    s_waitcnt vmcnt(3)
    v_xor_b32 v7, s55, v113
    v_bitop3_b32 v7, s55, v7, v115 bitop3:0xde
    v_cmp_ne_u32 s[60:61], 0, v7
    s_waitcnt vmcnt(2)
    v_xor_b32 v7, s55, v117
    v_bitop3_b32 v7, s55, v7, v119 bitop3:0xde
    v_cmp_ne_u32 s[62:63], 0, v7
    s_waitcnt vmcnt(1)
    v_xor_b32 v7, s55, v121
    v_bitop3_b32 v7, s55, v7, v123 bitop3:0xde
    v_cmp_ne_u32 s[64:65], 0, v7
    s_waitcnt vmcnt(0)
    v_xor_b32 v7, s55, v125
    v_bitop3_b32 v7, s55, v7, v127 bitop3:0xde
    v_cmp_ne_u32 s[66:67], 0, v7
MG_82:
    s_or_b64 vcc, s[50:51], s[52:53]
    s_or_b64 vcc, vcc, s[56:57]
    s_or_b64 vcc, vcc, s[58:59]
    s_or_b64 vcc, vcc, s[60:61]
    s_or_b64 vcc, vcc, s[62:63]
    s_or_b64 vcc, vcc, s[64:65]
    s_or_b64 vcc, vcc, s[66:67]
    s_cbranch_scc0 MGD_83
MI_84:
    s_wqm_b64 exec, s[50:51]
    s_cbranch_execz MS_85
    buffer_load_dwordx4 v[96:99], v1, s[44:47], s41 offen offset:0 sc1
MS_85:
    s_wqm_b64 exec, s[52:53]
    s_cbranch_execz MS_86
    buffer_load_dwordx4 v[100:103], v1, s[44:47], s41 offen offset:1024 sc1
MS_86:
    s_wqm_b64 exec, s[56:57]
    s_cbranch_execz MS_87
    buffer_load_dwordx4 v[104:107], v1, s[44:47], s41 offen offset:2048 sc1
MS_87:
    s_wqm_b64 exec, s[58:59]
    s_cbranch_execz MS_88
    buffer_load_dwordx4 v[108:111], v1, s[44:47], s41 offen offset:3072 sc1
MS_88:
    s_wqm_b64 exec, s[60:61]
    s_cbranch_execz MS_89
    buffer_load_dwordx4 v[112:115], v1, s[44:47], s42 offen offset:0 sc1
MS_89:
    s_wqm_b64 exec, s[62:63]
    s_cbranch_execz MS_90
    buffer_load_dwordx4 v[116:119], v1, s[44:47], s42 offen offset:1024 sc1
MS_90:
    s_wqm_b64 exec, s[64:65]
    s_cbranch_execz MS_91
    buffer_load_dwordx4 v[120:123], v1, s[44:47], s42 offen offset:2048 sc1
MS_91:
    s_wqm_b64 exec, s[66:67]
    s_cbranch_execz MS_92
    buffer_load_dwordx4 v[124:127], v1, s[44:47], s42 offen offset:3072 sc1
MS_92:
    s_waitcnt vmcnt(0)
    s_wqm_b64 exec, s[50:51]
    s_cbranch_execz MC_93
    v_xor_b32 v7, s55, v97
    v_bitop3_b32 v7, s55, v7, v99 bitop3:0xde
    v_cmp_ne_u32 s[50:51], 0, v7
MC_93:
    s_wqm_b64 exec, s[52:53]
    s_cbranch_execz MC_94
    v_xor_b32 v7, s55, v101
    v_bitop3_b32 v7, s55, v7, v103 bitop3:0xde
    v_cmp_ne_u32 s[52:53], 0, v7
MC_94:
    s_wqm_b64 exec, s[56:57]
    s_cbranch_execz MC_95
    v_xor_b32 v7, s55, v105
    v_bitop3_b32 v7, s55, v7, v107 bitop3:0xde
    v_cmp_ne_u32 s[56:57], 0, v7
MC_95:
    s_wqm_b64 exec, s[58:59]
    s_cbranch_execz MC_96
    v_xor_b32 v7, s55, v109
    v_bitop3_b32 v7, s55, v7, v111 bitop3:0xde
    v_cmp_ne_u32 s[58:59], 0, v7
MC_96:
    s_wqm_b64 exec, s[60:61]
    s_cbranch_execz MC_97
    v_xor_b32 v7, s55, v113
    v_bitop3_b32 v7, s55, v7, v115 bitop3:0xde
    v_cmp_ne_u32 s[60:61], 0, v7
MC_97:
    s_wqm_b64 exec, s[62:63]
    s_cbranch_execz MC_98
    v_xor_b32 v7, s55, v117
    v_bitop3_b32 v7, s55, v7, v119 bitop3:0xde
    v_cmp_ne_u32 s[62:63], 0, v7
MC_98:
    s_wqm_b64 exec, s[64:65]
    s_cbranch_execz MC_99
    v_xor_b32 v7, s55, v121
    v_bitop3_b32 v7, s55, v7, v123 bitop3:0xde
    v_cmp_ne_u32 s[64:65], 0, v7
MC_99:
    s_wqm_b64 exec, s[66:67]
    s_cbranch_execz MC_100
    v_xor_b32 v7, s55, v125
    v_bitop3_b32 v7, s55, v7, v127 bitop3:0xde
    v_cmp_ne_u32 s[66:67], 0, v7
MC_100:
    s_mov_b64 exec, -1
    s_sub_u32 s49, s49, 1
    s_cbranch_scc0 MG_82
MGD_83:
    v_max3_f32 v32, v96, v100, v104
    v_max3_f32 v33, v108, v112, v116
    v_max3_f32 v32, v32, v120, v124
    v_max_f32 v32, v32, v33
    s_nop 1
    v_max_f32_dpp v32, v32, v32 row_ror:8 row_mask:0xf bank_mask:0xf
    v_mov_b32 v33, v32
    s_nop 1
    v_permlane16_swap_b32 v32, v33
    s_nop 1
    v_max_f32 v32, v32, v33
    v_mov_b32 v33, v32
    s_nop 1
    v_permlane32_swap_b32 v32, v33
    s_nop 1
    v_max_f32 v32, v32, v33
    v_mul_f32 v32, v14, v32
    v_fma_f32 v16, v96, v14, -v32
    v_fma_f32 v17, v100, v14, -v32
    v_fma_f32 v18, v104, v14, -v32
    v_fma_f32 v19, v108, v14, -v32
    v_fma_f32 v20, v112, v14, -v32
    v_fma_f32 v21, v116, v14, -v32
    v_fma_f32 v22, v120, v14, -v32
    v_fma_f32 v23, v124, v14, -v32
    v_exp_f32 v16, v16
    v_exp_f32 v17, v17
    v_exp_f32 v18, v18
    v_exp_f32 v19, v19
    v_exp_f32 v20, v20
    v_exp_f32 v21, v21
    v_exp_f32 v22, v22
    v_exp_f32 v23, v23
    v_mul_f32 v36, v16, v98
    ds_write_b128 v1, v[16:19] offset:16384
    ds_write_b128 v1, v[20:23] offset:17408
    ds_write_b32 v4, v6 offset:39596
    v_fmac_f32 v36, v17, v102
    v_fmac_f32 v36, v18, v106
    v_fmac_f32 v36, v19, v110
    v_fmac_f32 v36, v20, v114
    v_fmac_f32 v36, v21, v118
    v_fmac_f32 v36, v22, v122
    v_fmac_f32 v36, v23, v126
    s_nop 1
    v_add_f32_dpp v36, v36, v36 row_ror:8 row_mask:0xf bank_mask:0xf
    v_mov_b32 v37, v36
    s_nop 1
    v_permlane16_swap_b32 v36, v37
    s_nop 1
    v_add_f32 v36, v36, v37
    v_mov_b32 v37, v36
    s_nop 1
    v_permlane32_swap_b32 v36, v37
    s_nop 1
    v_add_f32 v36, v36, v37
    v_rcp_f32 v37, v36
    v_mov_b32 v5, 2
    v_fma_f32 v38, -v36, v37, 1.0
    v_fma_f32 v37, v38, v37, v37
    ds_write_b32 v10, v37 offset:18432
    ds_write_b32 v4, v5 offset:39596
    s_branch L_fin
L_comb:
    s_lshl_b32 s40, s40, 5
    s_and_b32 s42, s4, 15
    s_lshl_b32 s42, s42, 1
    s_add_u32 s40, s40, s42
    s_and_b32 s42, s3, 1
    s_add_u32 s40, s40, s42
    s_mul_i32 s40, s40, 8448
    s_add_u32 s40, s40, 655360
    s_lshl_b32 s42, s42, 6
    v_lshrrev_b32 v8, 4, v0
    v_add_u32 v12, v10, v8
    v_lshlrev_b32 v12, 1, v12
    v_add_u32 v12, s42, v12
    s_add_u32 s43, s40, 4096
    v_mov_b32 v15, 0xff
    v_mov_b32 v64, 0
    v_mov_b32 v65, 0
    v_mov_b32 v66, 0
    v_mov_b32 v67, 0
    v_mov_b32 v68, 0
    v_mov_b32 v69, 0
    v_mov_b32 v70, 0
    v_mov_b32 v71, 0
    v_mov_b32 v72, 0
    v_mov_b32 v73, 0
    v_mov_b32 v74, 0
    v_mov_b32 v75, 0
    v_mov_b32 v76, 0
    v_mov_b32 v77, 0
    v_mov_b32 v78, 0
    v_mov_b32 v79, 0
    v_mov_b32 v80, 0
    v_mov_b32 v81, 0
    v_mov_b32 v82, 0
    v_mov_b32 v83, 0
    v_mov_b32 v84, 0
    v_mov_b32 v85, 0
    v_mov_b32 v86, 0
    v_mov_b32 v87, 0
    v_mov_b32 v88, 0
    v_mov_b32 v89, 0
    v_mov_b32 v90, 0
    v_mov_b32 v91, 0
    v_mov_b32 v92, 0
    v_mov_b32 v93, 0
    v_mov_b32 v94, 0
    v_mov_b32 v95, 0
    s_mov_b32 s49, 0x40000
W_101:
    ds_read_b32 v5, v4 offset:39560
    s_waitcnt lgkmcnt(0)
    v_readfirstlane_b32 s48, v5
    s_cmp_ge_u32 s48, 4
    s_cbranch_scc1 D_102
    s_sleep 1
    s_sub_u32 s49, s49, 1
    s_cbranch_scc0 W_101
D_102:
    s_mov_b32 s49, 0x40000
W_103:
    ds_read_b32 v5, v4 offset:39588
    s_waitcnt lgkmcnt(0)
    v_readfirstlane_b32 s48, v5
    s_cmp_ge_u32 s48, s53
    s_cbranch_scc1 D_104
    s_sleep 1
    s_sub_u32 s49, s49, 1
    s_cbranch_scc0 W_103
D_104:
    s_setprio 3
    s_mov_b32 s49, 0x20000
    s_mov_b64 s[50:51], -1
    s_mov_b64 s[52:53], -1
    s_mov_b64 s[56:57], 0
    s_mov_b64 s[58:59], 0
    s_mov_b64 s[60:61], 0
    s_mov_b64 s[62:63], 0
    s_mov_b64 s[64:65], 0
    s_mov_b64 s[66:67], 0
    s_cmp_lg_u32 s20, 0
    s_cbranch_scc1 MI_107
    buffer_load_dwordx4 v[64:67], v1, s[44:47], s40 offen offset:0 sc1
    buffer_load_dwordx4 v[68:71], v1, s[44:47], s40 offen offset:1024 sc1
    buffer_load_dwordx4 v[72:75], v1, s[44:47], s40 offen offset:2048 sc1
    buffer_load_dwordx4 v[76:79], v1, s[44:47], s40 offen offset:3072 sc1
    buffer_load_dwordx4 v[80:83], v1, s[44:47], s43 offen offset:0 sc1
    buffer_load_dwordx4 v[84:87], v1, s[44:47], s43 offen offset:1024 sc1
    buffer_load_dwordx4 v[88:91], v1, s[44:47], s43 offen offset:2048 sc1
    buffer_load_dwordx4 v[92:95], v1, s[44:47], s43 offen offset:3072 sc1
    s_waitcnt vmcnt(7)
    v_xor_b32 v64, s8, v64
    v_xor_b32 v65, s9, v65
    v_xor_b32 v66, s12, v66
    v_xor_b32 v67, s13, v67
    v_or3_b32 v5, v64, v65, v66
    v_bitop3_b32 v5, v5, v15, v67 bitop3:0xc8
    v_cmp_ne_u32 s[50:51], 0, v5
    s_waitcnt vmcnt(6)
    v_xor_b32 v68, s8, v68
    v_xor_b32 v69, s9, v69
    v_xor_b32 v70, s12, v70
    v_xor_b32 v71, s13, v71
    v_or3_b32 v5, v68, v69, v70
    v_bitop3_b32 v5, v5, v15, v71 bitop3:0xc8
    v_cmp_ne_u32 s[52:53], 0, v5
    s_waitcnt vmcnt(5)
    v_xor_b32 v72, s8, v72
    v_xor_b32 v73, s9, v73
    v_xor_b32 v74, s12, v74
    v_xor_b32 v75, s13, v75
    v_or3_b32 v5, v72, v73, v74
    v_bitop3_b32 v5, v5, v15, v75 bitop3:0xc8
    v_cmp_ne_u32 s[56:57], 0, v5
    s_waitcnt vmcnt(4)
    v_xor_b32 v76, s8, v76
    v_xor_b32 v77, s9, v77
    v_xor_b32 v78, s12, v78
    v_xor_b32 v79, s13, v79
    v_or3_b32 v5, v76, v77, v78
    v_bitop3_b32 v5, v5, v15, v79 bitop3:0xc8
    v_cmp_ne_u32 s[58:59], 0, v5
    s_waitcnt vmcnt(3)
    v_xor_b32 v80, s8, v80
    v_xor_b32 v81, s9, v81
    v_xor_b32 v82, s12, v82
    v_xor_b32 v83, s13, v83
    v_or3_b32 v5, v80, v81, v82
    v_bitop3_b32 v5, v5, v15, v83 bitop3:0xc8
    v_cmp_ne_u32 s[60:61], 0, v5
    s_waitcnt vmcnt(2)
    v_xor_b32 v84, s8, v84
    v_xor_b32 v85, s9, v85
    v_xor_b32 v86, s12, v86
    v_xor_b32 v87, s13, v87
    v_or3_b32 v5, v84, v85, v86
    v_bitop3_b32 v5, v5, v15, v87 bitop3:0xc8
    v_cmp_ne_u32 s[62:63], 0, v5
    s_waitcnt vmcnt(1)
    v_xor_b32 v88, s8, v88
    v_xor_b32 v89, s9, v89
    v_xor_b32 v90, s12, v90
    v_xor_b32 v91, s13, v91
    v_or3_b32 v5, v88, v89, v90
    v_bitop3_b32 v5, v5, v15, v91 bitop3:0xc8
    v_cmp_ne_u32 s[64:65], 0, v5
    s_waitcnt vmcnt(0)
    v_xor_b32 v92, s8, v92
    v_xor_b32 v93, s9, v93
    v_xor_b32 v94, s12, v94
    v_xor_b32 v95, s13, v95
    v_or3_b32 v5, v92, v93, v94
    v_bitop3_b32 v5, v5, v15, v95 bitop3:0xc8
    v_cmp_ne_u32 s[66:67], 0, v5
MG_105:
    s_or_b64 vcc, s[50:51], s[52:53]
    s_or_b64 vcc, vcc, s[56:57]
    s_or_b64 vcc, vcc, s[58:59]
    s_or_b64 vcc, vcc, s[60:61]
    s_or_b64 vcc, vcc, s[62:63]
    s_or_b64 vcc, vcc, s[64:65]
    s_or_b64 vcc, vcc, s[66:67]
    s_cbranch_scc0 MGD_106
MI_107:
    s_wqm_b64 exec, s[50:51]
    s_cbranch_execz MS_108
    buffer_load_dwordx4 v[64:67], v1, s[44:47], s40 offen offset:0 sc1
MS_108:
    s_wqm_b64 exec, s[52:53]
    s_cbranch_execz MS_109
    buffer_load_dwordx4 v[68:71], v1, s[44:47], s40 offen offset:1024 sc1
MS_109:
    s_wqm_b64 exec, s[56:57]
    s_cbranch_execz MS_110
    buffer_load_dwordx4 v[72:75], v1, s[44:47], s40 offen offset:2048 sc1
MS_110:
    s_wqm_b64 exec, s[58:59]
    s_cbranch_execz MS_111
    buffer_load_dwordx4 v[76:79], v1, s[44:47], s40 offen offset:3072 sc1
MS_111:
    s_wqm_b64 exec, s[60:61]
    s_cbranch_execz MS_112
    buffer_load_dwordx4 v[80:83], v1, s[44:47], s43 offen offset:0 sc1
MS_112:
    s_wqm_b64 exec, s[62:63]
    s_cbranch_execz MS_113
    buffer_load_dwordx4 v[84:87], v1, s[44:47], s43 offen offset:1024 sc1
MS_113:
    s_wqm_b64 exec, s[64:65]
    s_cbranch_execz MS_114
    buffer_load_dwordx4 v[88:91], v1, s[44:47], s43 offen offset:2048 sc1
MS_114:
    s_wqm_b64 exec, s[66:67]
    s_cbranch_execz MS_115
    buffer_load_dwordx4 v[92:95], v1, s[44:47], s43 offen offset:3072 sc1
MS_115:
    s_waitcnt vmcnt(0)
    s_wqm_b64 exec, s[50:51]
    s_cbranch_execz MC_116
    v_xor_b32 v64, s8, v64
    v_xor_b32 v65, s9, v65
    v_xor_b32 v66, s12, v66
    v_xor_b32 v67, s13, v67
    v_or3_b32 v5, v64, v65, v66
    v_bitop3_b32 v5, v5, v15, v67 bitop3:0xc8
    v_cmp_ne_u32 s[50:51], 0, v5
MC_116:
    s_wqm_b64 exec, s[52:53]
    s_cbranch_execz MC_117
    v_xor_b32 v68, s8, v68
    v_xor_b32 v69, s9, v69
    v_xor_b32 v70, s12, v70
    v_xor_b32 v71, s13, v71
    v_or3_b32 v5, v68, v69, v70
    v_bitop3_b32 v5, v5, v15, v71 bitop3:0xc8
    v_cmp_ne_u32 s[52:53], 0, v5
MC_117:
    s_wqm_b64 exec, s[56:57]
    s_cbranch_execz MC_118
    v_xor_b32 v72, s8, v72
    v_xor_b32 v73, s9, v73
    v_xor_b32 v74, s12, v74
    v_xor_b32 v75, s13, v75
    v_or3_b32 v5, v72, v73, v74
    v_bitop3_b32 v5, v5, v15, v75 bitop3:0xc8
    v_cmp_ne_u32 s[56:57], 0, v5
MC_118:
    s_wqm_b64 exec, s[58:59]
    s_cbranch_execz MC_119
    v_xor_b32 v76, s8, v76
    v_xor_b32 v77, s9, v77
    v_xor_b32 v78, s12, v78
    v_xor_b32 v79, s13, v79
    v_or3_b32 v5, v76, v77, v78
    v_bitop3_b32 v5, v5, v15, v79 bitop3:0xc8
    v_cmp_ne_u32 s[58:59], 0, v5
MC_119:
    s_wqm_b64 exec, s[60:61]
    s_cbranch_execz MC_120
    v_xor_b32 v80, s8, v80
    v_xor_b32 v81, s9, v81
    v_xor_b32 v82, s12, v82
    v_xor_b32 v83, s13, v83
    v_or3_b32 v5, v80, v81, v82
    v_bitop3_b32 v5, v5, v15, v83 bitop3:0xc8
    v_cmp_ne_u32 s[60:61], 0, v5
MC_120:
    s_wqm_b64 exec, s[62:63]
    s_cbranch_execz MC_121
    v_xor_b32 v84, s8, v84
    v_xor_b32 v85, s9, v85
    v_xor_b32 v86, s12, v86
    v_xor_b32 v87, s13, v87
    v_or3_b32 v5, v84, v85, v86
    v_bitop3_b32 v5, v5, v15, v87 bitop3:0xc8
    v_cmp_ne_u32 s[62:63], 0, v5
MC_121:
    s_wqm_b64 exec, s[64:65]
    s_cbranch_execz MC_122
    v_xor_b32 v88, s8, v88
    v_xor_b32 v89, s9, v89
    v_xor_b32 v90, s12, v90
    v_xor_b32 v91, s13, v91
    v_or3_b32 v5, v88, v89, v90
    v_bitop3_b32 v5, v5, v15, v91 bitop3:0xc8
    v_cmp_ne_u32 s[64:65], 0, v5
MC_122:
    s_wqm_b64 exec, s[66:67]
    s_cbranch_execz MC_123
    v_xor_b32 v92, s8, v92
    v_xor_b32 v93, s9, v93
    v_xor_b32 v94, s12, v94
    v_xor_b32 v95, s13, v95
    v_or3_b32 v5, v92, v93, v94
    v_bitop3_b32 v5, v5, v15, v95 bitop3:0xc8
    v_cmp_ne_u32 s[66:67], 0, v5
MC_123:
    s_mov_b64 exec, -1
    s_sub_u32 s49, s49, 1
    s_cbranch_scc0 MG_105
MGD_106:
    s_mov_b32 s49, 0x40000
L_ww:
    ds_read_b32 v5, v4 offset:39596
    ds_read_b128 v[16:19], v1 offset:16384
    ds_read_b128 v[20:23], v1 offset:17408
    s_waitcnt lgkmcnt(0)
    v_readfirstlane_b32 s48, v5
    s_cmp_ge_u32 s48, 1
    s_cbranch_scc1 L_wwd
    s_sub_u32 s49, s49, 1
    s_cbranch_scc0 L_ww
L_wwd:
    v_mul_f32 v32, v16, v64
    v_mul_f32 v33, v16, v65
    v_mul_f32 v34, v16, v66
    v_mul_f32 v35, v16, v67
    v_fmac_f32 v32, v17, v68
    v_fmac_f32 v33, v17, v69
    v_fmac_f32 v34, v17, v70
    v_fmac_f32 v35, v17, v71
    v_fmac_f32 v32, v18, v72
    v_fmac_f32 v33, v18, v73
    v_fmac_f32 v34, v18, v74
    v_fmac_f32 v35, v18, v75
    v_fmac_f32 v32, v19, v76
    v_fmac_f32 v33, v19, v77
    v_fmac_f32 v34, v19, v78
    v_fmac_f32 v35, v19, v79
    v_fmac_f32 v32, v20, v80
    v_fmac_f32 v33, v20, v81
    v_fmac_f32 v34, v20, v82
    v_fmac_f32 v35, v20, v83
    ds_read_b32 v5, v4 offset:39596
    ds_read_b32 v37, v10 offset:18432
    v_fmac_f32 v32, v21, v84
    v_fmac_f32 v33, v21, v85
    v_fmac_f32 v34, v21, v86
    v_fmac_f32 v35, v21, v87
    v_fmac_f32 v32, v22, v88
    v_fmac_f32 v33, v22, v89
    v_fmac_f32 v34, v22, v90
    v_fmac_f32 v35, v22, v91
    v_fmac_f32 v32, v23, v92
    v_fmac_f32 v33, v23, v93
    v_fmac_f32 v34, v23, v94
    v_fmac_f32 v35, v23, v95
    s_nop 1
    v_permlane16_swap_b32 v32, v33
    v_permlane16_swap_b32 v34, v35
    s_nop 0
    v_add_f32 v32, v32, v33
    v_add_f32 v34, v34, v35
    s_nop 1
    v_permlane32_swap_b32 v32, v34
    s_nop 1
    v_add_f32 v32, v32, v34
    s_nop 1
    v_add_f32_dpp v32, v32, v32 row_ror:8 row_mask:0xf bank_mask:0xf
    s_waitcnt lgkmcnt(0)
    v_readfirstlane_b32 s48, v5
    s_cmp_ge_u32 s48, 2
    s_cbranch_scc1 L_rok
    s_mov_b32 s49, 0x40000
W_124:
    ds_read_b32 v5, v4 offset:39596
    s_waitcnt lgkmcnt(0)
    v_readfirstlane_b32 s48, v5
    s_cmp_ge_u32 s48, 2
    s_cbranch_scc1 D_125
    s_sub_u32 s49, s49, 1
    s_cbranch_scc0 W_124
D_125:
    ds_read_b32 v37, v10 offset:18432
    s_waitcnt lgkmcnt(0)
L_rok:
    v_mul_f32 v32, v32, v37
    v_cvt_pk_bf16_f32 v32, v32, v32
    s_mov_b64 exec, s[14:15]
    ds_write_b16 v12, v32 offset:39680
    s_mov_b64 exec, 1
    ds_add_u32 v4, v6 offset:39576
    s_mov_b64 exec, -1
    s_branch L_fin
L_red:
    s_bfe_u32 s40, s2, 0x20003
    s_cmp_lg_u32 s40, 0
    s_cbranch_scc1 L_fin
    s_lshr_b32 s40, s2, 5
    s_lshl_b32 s40, s40, 3
    s_and_b32 s41, s2, 7
    s_add_u32 s40, s40, s41
    s_lshl_b32 s42, s40, 6
    v_lshrrev_b32 v8, 4, v0
    v_add_u32 v12, v10, v8
    v_lshlrev_b32 v12, 1, v12
    v_add_u32 v12, s42, v12
    s_mul_i32 s40, s40, 8448
    s_add_u32 s40, s40, 2883584
    v_mov_b32 v13, s55
    v_mov_b32 v15, 0xff
    s_add_u32 s43, s40, 4096
    buffer_load_dwordx4 v[64:67], v1, s[44:47], s40 offen offset:0 sc1
    buffer_load_dwordx4 v[68:71], v1, s[44:47], s40 offen offset:1024 sc1
    buffer_load_dwordx4 v[72:75], v1, s[44:47], s40 offen offset:2048 sc1
    buffer_load_dwordx4 v[76:79], v1, s[44:47], s40 offen offset:3072 sc1
    buffer_load_dwordx4 v[80:83], v1, s[44:47], s43 offen offset:0 sc1
    buffer_load_dwordx4 v[84:87], v1, s[44:47], s43 offen offset:1024 sc1
    buffer_load_dwordx4 v[88:91], v1, s[44:47], s43 offen offset:2048 sc1
    buffer_load_dwordx4 v[92:95], v1, s[44:47], s43 offen offset:3072 sc1
    s_waitcnt vmcnt(0)
    s_mov_b32 s49, 0x40000
W_126:
    ds_read_b32 v5, v4 offset:39588
    s_waitcnt lgkmcnt(0)
    v_readfirstlane_b32 s48, v5
    s_cmp_ge_u32 s48, 8
    s_cbranch_scc1 D_127
    s_sleep 1
    s_sub_u32 s49, s49, 1
    s_cbranch_scc0 W_126
D_127:
    s_mov_b32 s49, 0x40000
W_128:
    ds_read_b32 v5, v4 offset:39576
    s_waitcnt lgkmcnt(0)
    v_readfirstlane_b32 s48, v5
    s_cmp_ge_u32 s48, 2
    s_cbranch_scc1 D_129
    s_sleep 1
    s_sub_u32 s49, s49, 1
    s_cbranch_scc0 W_128
D_129:
    s_setprio 3
    s_mov_b32 s49, 0x20000
    buffer_load_dwordx4 v[64:67], v1, s[44:47], s40 offen offset:0 sc1
    buffer_load_dwordx4 v[68:71], v1, s[44:47], s40 offen offset:1024 sc1
    buffer_load_dwordx4 v[72:75], v1, s[44:47], s40 offen offset:2048 sc1
    buffer_load_dwordx4 v[76:79], v1, s[44:47], s40 offen offset:3072 sc1
    buffer_load_dwordx4 v[80:83], v1, s[44:47], s43 offen offset:0 sc1
    buffer_load_dwordx4 v[84:87], v1, s[44:47], s43 offen offset:1024 sc1
    buffer_load_dwordx4 v[88:91], v1, s[44:47], s43 offen offset:2048 sc1
    buffer_load_dwordx4 v[92:95], v1, s[44:47], s43 offen offset:3072 sc1
    s_waitcnt vmcnt(7)
    v_xor_b32 v64, s8, v64
    v_xor_b32 v65, s9, v65
    v_xor_b32 v66, s12, v66
    v_xor_b32 v67, s13, v67
    v_or3_b32 v5, v64, v65, v66
    v_bitop3_b32 v5, v5, v15, v67 bitop3:0xc8
    v_cmp_ne_u32 s[50:51], 0, v5
    s_waitcnt vmcnt(6)
    v_xor_b32 v68, s8, v68
    v_xor_b32 v69, s9, v69
    v_xor_b32 v70, s12, v70
    v_xor_b32 v71, s13, v71
    v_or3_b32 v5, v68, v69, v70
    v_bitop3_b32 v5, v5, v15, v71 bitop3:0xc8
    v_cmp_ne_u32 s[52:53], 0, v5
    s_waitcnt vmcnt(5)
    v_xor_b32 v72, s8, v72
    v_xor_b32 v73, s9, v73
    v_xor_b32 v74, s12, v74
    v_xor_b32 v75, s13, v75
    v_or3_b32 v5, v72, v73, v74
    v_bitop3_b32 v5, v5, v15, v75 bitop3:0xc8
    v_cmp_ne_u32 s[56:57], 0, v5
    s_waitcnt vmcnt(4)
    v_xor_b32 v76, s8, v76
    v_xor_b32 v77, s9, v77
    v_xor_b32 v78, s12, v78
    v_xor_b32 v79, s13, v79
    v_or3_b32 v5, v76, v77, v78
    v_bitop3_b32 v5, v5, v15, v79 bitop3:0xc8
    v_cmp_ne_u32 s[58:59], 0, v5
    s_waitcnt vmcnt(3)
    v_xor_b32 v80, s8, v80
    v_xor_b32 v81, s9, v81
    v_xor_b32 v82, s12, v82
    v_xor_b32 v83, s13, v83
    v_or3_b32 v5, v80, v81, v82
    v_bitop3_b32 v5, v5, v15, v83 bitop3:0xc8
    v_cmp_ne_u32 s[60:61], 0, v5
    s_waitcnt vmcnt(2)
    v_xor_b32 v84, s8, v84
    v_xor_b32 v85, s9, v85
    v_xor_b32 v86, s12, v86
    v_xor_b32 v87, s13, v87
    v_or3_b32 v5, v84, v85, v86
    v_bitop3_b32 v5, v5, v15, v87 bitop3:0xc8
    v_cmp_ne_u32 s[62:63], 0, v5
    s_waitcnt vmcnt(1)
    v_xor_b32 v88, s8, v88
    v_xor_b32 v89, s9, v89
    v_xor_b32 v90, s12, v90
    v_xor_b32 v91, s13, v91
    v_or3_b32 v5, v88, v89, v90
    v_bitop3_b32 v5, v5, v15, v91 bitop3:0xc8
    v_cmp_ne_u32 s[64:65], 0, v5
    s_waitcnt vmcnt(0)
    v_xor_b32 v92, s8, v92
    v_xor_b32 v93, s9, v93
    v_xor_b32 v94, s12, v94
    v_xor_b32 v95, s13, v95
    v_or3_b32 v5, v92, v93, v94
    v_bitop3_b32 v5, v5, v15, v95 bitop3:0xc8
    v_cmp_ne_u32 s[66:67], 0, v5
MG_130:
    s_or_b64 vcc, s[50:51], s[52:53]
    s_or_b64 vcc, vcc, s[56:57]
    s_or_b64 vcc, vcc, s[58:59]
    s_or_b64 vcc, vcc, s[60:61]
    s_or_b64 vcc, vcc, s[62:63]
    s_or_b64 vcc, vcc, s[64:65]
    s_or_b64 vcc, vcc, s[66:67]
    s_cbranch_scc0 MGD_131
MI_132:
    s_wqm_b64 exec, s[50:51]
    s_cbranch_execz MS_133
    buffer_load_dwordx4 v[64:67], v1, s[44:47], s40 offen offset:0 sc1
MS_133:
    s_wqm_b64 exec, s[52:53]
    s_cbranch_execz MS_134
    buffer_load_dwordx4 v[68:71], v1, s[44:47], s40 offen offset:1024 sc1
MS_134:
    s_wqm_b64 exec, s[56:57]
    s_cbranch_execz MS_135
    buffer_load_dwordx4 v[72:75], v1, s[44:47], s40 offen offset:2048 sc1
MS_135:
    s_wqm_b64 exec, s[58:59]
    s_cbranch_execz MS_136
    buffer_load_dwordx4 v[76:79], v1, s[44:47], s40 offen offset:3072 sc1
MS_136:
    s_wqm_b64 exec, s[60:61]
    s_cbranch_execz MS_137
    buffer_load_dwordx4 v[80:83], v1, s[44:47], s43 offen offset:0 sc1
MS_137:
    s_wqm_b64 exec, s[62:63]
    s_cbranch_execz MS_138
    buffer_load_dwordx4 v[84:87], v1, s[44:47], s43 offen offset:1024 sc1
MS_138:
    s_wqm_b64 exec, s[64:65]
    s_cbranch_execz MS_139
    buffer_load_dwordx4 v[88:91], v1, s[44:47], s43 offen offset:2048 sc1
MS_139:
    s_wqm_b64 exec, s[66:67]
    s_cbranch_execz MS_140
    buffer_load_dwordx4 v[92:95], v1, s[44:47], s43 offen offset:3072 sc1
MS_140:
    s_waitcnt vmcnt(0)
    s_wqm_b64 exec, s[50:51]
    s_cbranch_execz MC_141
    v_xor_b32 v64, s8, v64
    v_xor_b32 v65, s9, v65
    v_xor_b32 v66, s12, v66
    v_xor_b32 v67, s13, v67
    v_or3_b32 v5, v64, v65, v66
    v_bitop3_b32 v5, v5, v15, v67 bitop3:0xc8
    v_cmp_ne_u32 s[50:51], 0, v5
MC_141:
    s_wqm_b64 exec, s[52:53]
    s_cbranch_execz MC_142
    v_xor_b32 v68, s8, v68
    v_xor_b32 v69, s9, v69
    v_xor_b32 v70, s12, v70
    v_xor_b32 v71, s13, v71
    v_or3_b32 v5, v68, v69, v70
    v_bitop3_b32 v5, v5, v15, v71 bitop3:0xc8
    v_cmp_ne_u32 s[52:53], 0, v5
MC_142:
    s_wqm_b64 exec, s[56:57]
    s_cbranch_execz MC_143
    v_xor_b32 v72, s8, v72
    v_xor_b32 v73, s9, v73
    v_xor_b32 v74, s12, v74
    v_xor_b32 v75, s13, v75
    v_or3_b32 v5, v72, v73, v74
    v_bitop3_b32 v5, v5, v15, v75 bitop3:0xc8
    v_cmp_ne_u32 s[56:57], 0, v5
MC_143:
    s_wqm_b64 exec, s[58:59]
    s_cbranch_execz MC_144
    v_xor_b32 v76, s8, v76
    v_xor_b32 v77, s9, v77
    v_xor_b32 v78, s12, v78
    v_xor_b32 v79, s13, v79
    v_or3_b32 v5, v76, v77, v78
    v_bitop3_b32 v5, v5, v15, v79 bitop3:0xc8
    v_cmp_ne_u32 s[58:59], 0, v5
MC_144:
    s_wqm_b64 exec, s[60:61]
    s_cbranch_execz MC_145
    v_xor_b32 v80, s8, v80
    v_xor_b32 v81, s9, v81
    v_xor_b32 v82, s12, v82
    v_xor_b32 v83, s13, v83
    v_or3_b32 v5, v80, v81, v82
    v_bitop3_b32 v5, v5, v15, v83 bitop3:0xc8
    v_cmp_ne_u32 s[60:61], 0, v5
MC_145:
    s_wqm_b64 exec, s[62:63]
    s_cbranch_execz MC_146
    v_xor_b32 v84, s8, v84
    v_xor_b32 v85, s9, v85
    v_xor_b32 v86, s12, v86
    v_xor_b32 v87, s13, v87
    v_or3_b32 v5, v84, v85, v86
    v_bitop3_b32 v5, v5, v15, v87 bitop3:0xc8
    v_cmp_ne_u32 s[62:63], 0, v5
MC_146:
    s_wqm_b64 exec, s[64:65]
    s_cbranch_execz MC_147
    v_xor_b32 v88, s8, v88
    v_xor_b32 v89, s9, v89
    v_xor_b32 v90, s12, v90
    v_xor_b32 v91, s13, v91
    v_or3_b32 v5, v88, v89, v90
    v_bitop3_b32 v5, v5, v15, v91 bitop3:0xc8
    v_cmp_ne_u32 s[64:65], 0, v5
MC_147:
    s_wqm_b64 exec, s[66:67]
    s_cbranch_execz MC_148
    v_xor_b32 v92, s8, v92
    v_xor_b32 v93, s9, v93
    v_xor_b32 v94, s12, v94
    v_xor_b32 v95, s13, v95
    v_or3_b32 v5, v92, v93, v94
    v_bitop3_b32 v5, v5, v15, v95 bitop3:0xc8
    v_cmp_ne_u32 s[66:67], 0, v5
MC_148:
    s_mov_b64 exec, -1
    s_sub_u32 s49, s49, 1
    s_cbranch_scc0 MG_130
MGD_131:
    v_pk_add_f32 v[40:41], v[64:65], v[80:81]
    v_pk_add_f32 v[42:43], v[66:67], v[82:83]
    v_pk_add_f32 v[44:45], v[68:69], v[84:85]
    v_pk_add_f32 v[46:47], v[70:71], v[86:87]
    v_pk_add_f32 v[48:49], v[72:73], v[88:89]
    v_pk_add_f32 v[50:51], v[74:75], v[90:91]
    v_pk_add_f32 v[52:53], v[76:77], v[92:93]
    v_pk_add_f32 v[54:55], v[78:79], v[94:95]
    v_pk_add_f32 v[40:41], v[40:41], v[48:49]
    v_pk_add_f32 v[42:43], v[42:43], v[50:51]
    v_pk_add_f32 v[44:45], v[44:45], v[52:53]
    v_pk_add_f32 v[46:47], v[46:47], v[54:55]
    v_pk_add_f32 v[40:41], v[40:41], v[44:45]
    v_pk_add_f32 v[42:43], v[42:43], v[46:47]
    s_nop 1
    v_permlane16_swap_b32 v40, v41
    v_permlane16_swap_b32 v42, v43
    s_nop 0
    v_add_f32 v40, v40, v41
    v_add_f32 v42, v42, v43
    s_nop 1
    v_permlane32_swap_b32 v40, v42
    s_nop 1
    v_add_f32 v40, v40, v42
    s_nop 1
    v_add_f32_dpp v40, v40, v40 row_ror:8 row_mask:0xf bank_mask:0xf
    v_cvt_pk_bf16_f32 v32, v40, v40
    s_mov_b64 exec, s[14:15]
    global_store_short v12, v32, s[24:25]
    s_cmp_lg_u32 s2, 0
    s_cbranch_scc1 L_nogen
    s_mov_b64 exec, 1
    global_store_dword v4, v13, s[28:29]
L_nogen:
    s_mov_b64 exec, -1
L_fin:
L_end:
    s_endpgm
.section .rodata,"a"
.p2align 6
.amdhsa_kernel concat_heads__gqa_block_cached__sliding_block_cached__decode_kernel
  .amdhsa_next_free_vgpr 128
  .amdhsa_next_free_sgpr 102
  .amdhsa_accum_offset 128
  .amdhsa_group_segment_fixed_size 0
  .amdhsa_kernarg_size 104
  .amdhsa_user_sgpr_count 2
  .amdhsa_user_sgpr_kernarg_segment_ptr 1
  .amdhsa_system_sgpr_workgroup_id_x 1
.end_amdhsa_kernel
```
